```python
import torch

def _softmax(x, axis=-1):
    return torch.softmax(x, dim=axis)
def _gelu(x):
    return torch.nn.functional.gelu(x, approximate="tanh")
def _silu(x):
    return torch.nn.functional.silu(x)
def _sigmoid(x):
    return torch.sigmoid(x)
def _layernorm(x, axis=-1, eps=1e-5):
    m = x.mean(dim=axis, keepdim=True)
    v = x.var(dim=axis, keepdim=True, unbiased=False)
    return (x - m) / torch.sqrt(v + eps)
def _scatter_add(tgt, idx, src, axis=0):
    return tgt.clone().index_add_(axis, idx, src)
def _segment_sum(src, seg, n):
    out = torch.zeros((n,) + src.shape[1:], dtype=src.dtype)
    return out.index_add_(0, seg, src)
def _pad(x, pw):
    flat = tuple(v for pair in reversed(pw) for v in pair)
    return torch.nn.functional.pad(x, flat)

kernel_name = 'gated_mix__grouped_kv_mqa__linear_kernel_hedgehog__prompt'

def setup_inputs():

    _w = (lambda a: (lambda t: t.to(torch.bfloat16) if t.is_floating_point() else t)(torch.as_tensor(a)))
    def _A_setup():
        B, S, D, H = 1, 2048, 512, 32
        Dh = D // H
        return {
            "x": _w((lambda *s: torch.randn(*s, dtype=torch.bfloat16) * 0.05)(B, S, D)),
            "wq": _w((lambda *s: torch.randn(*s, dtype=torch.bfloat16) * 1.6)(D, H * Dh)),
            "wk": _w((lambda *s: torch.randn(*s, dtype=torch.bfloat16) * 1.6)(D, Dh)),
            "wv": _w((lambda *s: torch.randn(*s, dtype=torch.bfloat16) * 0.05)(D, Dh)),
            "wo": _w((lambda *s: torch.randn(*s, dtype=torch.bfloat16) * 0.05)(H * Dh, D)),
        }
    _A_in = _A_setup()

    def _B_setup():
        B, S, D, H = 1, 2048, 512, 32
        Dh = D // H
        return {
            "x": _w((lambda *s: torch.randn(*s, dtype=torch.bfloat16) * 0.05)(B, S, D)),
            "wqkv": _w((lambda *s: torch.randn(*s, dtype=torch.bfloat16) * 1.6)(D, 3 * D)),
            "w_phi": _w((lambda *s: torch.randn(*s, dtype=torch.bfloat16) * 1.6)(H, Dh, Dh) * (Dh ** -0.5)),
            "wo": _w((lambda *s: torch.randn(*s, dtype=torch.bfloat16) * 0.05)(D, D)),
        }
    _B_in = _B_setup()

    return {
        "A_x": _A_in["x"],
        "A_wq": _A_in["wq"],
        "A_wk": _A_in["wk"],
        "A_wv": _A_in["wv"],
        "A_wo": _A_in["wo"],
        "B_x": _B_in["x"],
        "B_wqkv": _B_in["wqkv"],
        "B_w_phi": _B_in["w_phi"],
        "B_wo": _B_in["wo"],
        "gate_w": _w((lambda *s: torch.randn(*s, dtype=torch.bfloat16) * 0.05)(512) * 16.0),
    }

def reference(A_x, A_wq, A_wk, A_wv, A_wo, B_x, B_wqkv, B_w_phi, B_wo, gate_w):
    def _A_ref(x, wq, wk, wv, wo):
        B, S, D = x.shape
        H = 32
        Dh = D // H
        q = (lambda x, *d: x.permute(*d))((x @ wq).reshape(B, S, H, Dh), 0, 2, 1, 3)
        k = x @ wk
        v = x @ wv
        scores = torch.einsum("bhqd,bkd->bhqk", q, k) * (Dh ** -0.5)
        p = _softmax(scores, axis=-1)
        o = torch.einsum("bhqk,bkd->bhqd", p, v)
        return (lambda x, *d: x.permute(*d))(o, 0, 2, 1, 3).reshape(B, S, H * Dh) @ wo

    def _B_ref(x, wqkv, w_phi, wo):
        B, S, D = x.shape
        H = 32; Dh = D // H
        qkv = (lambda x, *d: x.permute(*d))((x @ wqkv).reshape(B, S, 3, H, Dh), 2, 0, 3, 1, 4)
        q, k, v = qkv[0], qkv[1], qkv[2]
        pq = torch.einsum("bhsd,hdf->bhsf", q, w_phi)
        pk = torch.einsum("bhsd,hdf->bhsf", k, w_phi)
        phi_q = torch.concatenate([_softmax(pq, axis=-1), _softmax(-pq, axis=-1)], axis=-1)
        phi_k = torch.concatenate([_softmax(pk, axis=-1), _softmax(-pk, axis=-1)], axis=-1)
        kv = torch.einsum("bhsf,bhsd->bhfd", phi_k, v)
        z  = torch.einsum("bhsf->bhf", phi_k)
        num = torch.einsum("bhqf,bhfd->bhqd", phi_q, kv)
        den = torch.einsum("bhqf,bhf->bhq", phi_q, z)[..., None] + 1e-6
        o = num / den
        return (lambda x, *d: x.permute(*d))(o, 0, 2, 1, 3).reshape(B, S, D) @ wo

    x = A_x
    g = _sigmoid((x * gate_w).sum(-1, keepdims=True))
    a = _A_ref(x, A_wq, A_wk, A_wv, A_wo)
    b = _B_ref(x, B_wqkv, B_w_phi, B_wo)
    return g * a + (1 - g) * b
```

```asm
; @launch grid=(256,1,1) block=(512,1,1) lds=163840
.amdgcn_target "amdgcn-amd-amdhsa--gfx950"
.text
.p2align 12
.fill 832, 4, 0xbf810000
.globl gated_mix__grouped_kv_mqa__linear_kernel_hedgehog__prompt_kernel
.p2align 8
.type gated_mix__grouped_kv_mqa__linear_kernel_hedgehog__prompt_kernel,@function
gated_mix__grouped_kv_mqa__linear_kernel_hedgehog__prompt_kernel:
    s_cmp_ge_u32 s2, 256
    s_cbranch_scc1 L_exit
    s_load_dwordx16 s[4:19], s[0:1], 0
    s_load_dwordx8 s[20:27], s[0:1], 64
    s_load_dwordx2 s[28:29], s[0:1], 96
    v_lshrrev_b32 v1, 6, v0
    v_and_b32 v0, 63, v0
    v_readfirstlane_b32 s72, v1
    s_and_b32 s81, s2, 7
    s_lshr_b32 s82, s2, 3
    s_lshl_b32 s83, s81, 2
    s_lshr_b32 s84, s82, 3
    s_add_u32 s73, s83, s84
    s_and_b32 s74, s82, 7
    s_and_b32 s86, s82, 3
    v_lshlrev_b32 v10, 4, v0
    s_cmp_lg_u32 s72, 0
    s_cbranch_scc1 L_w17
    s_mul_i32 s93, s86, 16640
    s_lshl_b32 s94, s73, 16
    s_lshl_b32 s83, s86, 14
    s_add_u32 s94, s94, s83
    s_mov_b32 m0, 66560
    s_waitcnt lgkmcnt(0)
    global_load_lds_dwordx4 v10, s[22:23]
    s_mov_b32 s32, s4
    s_mov_b32 s33, s5
    s_mov_b32 s34, 0x200000
    s_mov_b32 s35, 0x20000
    s_add_u32 m0, s93, 0
    s_nop 0
    buffer_load_dwordx4 v10, s[32:35], s94 offen offset:0 nt lds
    s_add_u32 m0, s93, 16
    s_nop 0
    buffer_load_dwordx4 v10, s[32:35], s94 offen offset:1024 nt lds
    s_add_u32 m0, s93, 32
    s_nop 0
    buffer_load_dwordx4 v10, s[32:35], s94 offen offset:2048 nt lds
    s_add_u32 m0, s93, 48
    s_nop 0
    buffer_load_dwordx4 v10, s[32:35], s94 offen offset:3072 nt lds
    s_add_u32 m0, s93, 4160
    s_add_u32 s94, s94, 4096
    buffer_load_dwordx4 v10, s[32:35], s94 offen offset:0 nt lds
    s_add_u32 m0, s93, 4176
    s_nop 0
    buffer_load_dwordx4 v10, s[32:35], s94 offen offset:1024 nt lds
    s_add_u32 m0, s93, 4192
    s_nop 0
    buffer_load_dwordx4 v10, s[32:35], s94 offen offset:2048 nt lds
    s_add_u32 m0, s93, 4208
    s_nop 0
    buffer_load_dwordx4 v10, s[32:35], s94 offen offset:3072 nt lds
    s_add_u32 m0, s93, 8320
    s_add_u32 s94, s94, 4096
    buffer_load_dwordx4 v10, s[32:35], s94 offen offset:0 nt lds
    s_add_u32 m0, s93, 8336
    s_nop 0
    buffer_load_dwordx4 v10, s[32:35], s94 offen offset:1024 nt lds
    s_add_u32 m0, s93, 8352
    s_nop 0
    buffer_load_dwordx4 v10, s[32:35], s94 offen offset:2048 nt lds
    s_add_u32 m0, s93, 8368
    s_nop 0
    buffer_load_dwordx4 v10, s[32:35], s94 offen offset:3072 nt lds
    s_add_u32 m0, s93, 12480
    s_add_u32 s94, s94, 4096
    buffer_load_dwordx4 v10, s[32:35], s94 offen offset:0 nt lds
    s_add_u32 m0, s93, 12496
    s_nop 0
    buffer_load_dwordx4 v10, s[32:35], s94 offen offset:1024 nt lds
    s_add_u32 m0, s93, 12512
    s_nop 0
    buffer_load_dwordx4 v10, s[32:35], s94 offen offset:2048 nt lds
    s_add_u32 m0, s93, 12528
    s_nop 0
    buffer_load_dwordx4 v10, s[32:35], s94 offen offset:3072 nt lds
    s_bitcmp1_b32 s74, 2
    s_cselect_b32 s40, s10, s8
    s_cselect_b32 s41, s11, s9
    s_mov_b32 s42, 0x4000
    s_mov_b32 s43, 0x20000
    s_mov_b32 m0, 74752
    s_mov_b32 s82, 0
    buffer_load_dwordx4 v10, s[40:43], s82 offen offset:0 lds
    buffer_load_dwordx4 v10, s[40:43], s82 offen offset:1024 lds
    buffer_load_dwordx4 v10, s[40:43], s82 offen offset:2048 lds
    buffer_load_dwordx4 v10, s[40:43], s82 offen offset:3072 lds
    s_mov_b32 m0, 78848
    s_mov_b32 s82, 4096
    buffer_load_dwordx4 v10, s[40:43], s82 offen offset:0 lds
    buffer_load_dwordx4 v10, s[40:43], s82 offen offset:1024 lds
    buffer_load_dwordx4 v10, s[40:43], s82 offen offset:2048 lds
    buffer_load_dwordx4 v10, s[40:43], s82 offen offset:3072 lds
    s_mov_b32 m0, 82944
    s_mov_b32 s82, 8192
    buffer_load_dwordx4 v10, s[40:43], s82 offen offset:0 lds
    buffer_load_dwordx4 v10, s[40:43], s82 offen offset:1024 lds
    buffer_load_dwordx4 v10, s[40:43], s82 offen offset:2048 lds
    buffer_load_dwordx4 v10, s[40:43], s82 offen offset:3072 lds
    s_mov_b32 m0, 87040
    s_mov_b32 s82, 12288
    buffer_load_dwordx4 v10, s[40:43], s82 offen offset:0 lds
    buffer_load_dwordx4 v10, s[40:43], s82 offen offset:1024 lds
    buffer_load_dwordx4 v10, s[40:43], s82 offen offset:2048 lds
    buffer_load_dwordx4 v10, s[40:43], s82 offen offset:3072 lds
    s_branch L_aw0b
L_w17:
    s_cmp_eq_u32 s72, 3
    s_cbranch_scc1 L_aw3
    s_cmp_lt_u32 s72, 3
    s_cbranch_scc1 L_aw12
    s_getpc_b64 s[68:69]
L_pc:
    s_lshl_b32 s81, s82, 2
    s_add_u32 s81, s81, s72
    s_sub_u32 s81, s81, 3
    s_mul_i32 s81, s81, 384
    s_min_u32 s81, s81, CODE_END - L_pc - 384
    s_add_u32 s68, s68, s81
    s_addc_u32 s69, s69, 0
    s_load_dword s96, s[68:69], 0
    s_load_dword s97, s[68:69], 64
    s_load_dword s98, s[68:69], 128
    s_load_dword s99, s[68:69], 192
    s_load_dword s98, s[68:69], 256
    s_load_dword s99, s[68:69], 320
    s_branch L_sw
L_aw3:
    s_cmp_lg_u32 s2, 0
    s_cbranch_scc1 L_nononce
    s_memrealtime s[82:83]
    v_mov_b32 v13, 0
    s_waitcnt lgkmcnt(0)
    s_or_b32 s82, s82, 1
    v_mov_b32 v14, s82
    s_mov_b64 exec, 1
    global_store_dword v13, v14, s[26:27] sc1
    s_mov_b64 exec, -1
L_nononce:
    s_lshl_b32 s81, s74, 11
    v_add_u32 v11, s81, v10
    s_lshl_b32 s81, s2, 11
    v_lshl_add_u32 v12, v0, 7, s81
    s_lshl_b32 s81, s73, 7
    s_add_u32 s81, s81, 524288
    v_mov_b32 v13, s81
    s_waitcnt lgkmcnt(0)
    s_mov_b32 m0, 161792
    s_mov_b64 exec, 0xffff
    global_load_dword v20, v12, s[6:7]
    s_mov_b64 exec, 1
    global_load_dword v21, v13, s[28:29]
    s_mov_b64 exec, -1
    global_load_lds_dwordx4 v11, s[18:19]
    global_load_lds_dwordx4 v11, s[18:19] offset:1024
    s_branch L_aw3b
L_aw0b:
    v_lshrrev_b32 v11, 3, v0
    v_and_b32 v12, 7, v0
    v_lshrrev_b32 v13, 2, v0
    v_and_b32 v13, 4, v13
    v_xor_b32 v12, v12, v13
    v_lshlrev_b32 v12, 4, v12
    v_lshl_add_u32 v9, v11, 10, v12
    v_mul_u32_u24 v8, 3072, v11
    v_add_u32 v8, v8, v12
    v_mov_b32 v11, v9
    s_lshr_b32 s78, s72, 1
    s_lshl_b32 s79, s78, 13
    s_lshl_b32 s87, s78, 16
    s_lshl_b32 s83, s74, 7
    s_add_u32 s87, s87, s83
    s_mov_b32 s36, s6
    s_mov_b32 s37, s7
    s_mov_b32 s38, 0x80000
    s_mov_b32 s39, 0x20000
    s_lshl_b32 s75, s73, 3
    s_add_u32 s75, s75, s74
    s_mov_b32 s77, 400000
    s_lshl_b32 s92, s75, 7
    s_add_u32 s92, s92, 524288
    s_mov_b32 s56, s28
    s_mov_b32 s57, s29
    s_mov_b32 s58, 0x800000
    s_mov_b32 s59, 0x20000
    s_mov_b32 s64, s26
    s_mov_b32 s65, s27
    s_mov_b32 s66, 0x100
    s_mov_b32 s67, 0x20000
    v_and_b32 v16, 15, v0
    v_lshrrev_b32 v14, 4, v0
    s_lshl_b32 s81, s86, 4
    v_add_u32 v13, s81, v16
    v_mul_u32_u24 v15, 1040, v13
    v_lshl_add_u32 v15, v14, 4, v15
    v_lshlrev_b32 v19, 3, v16
    v_lshl_add_u32 v19, v14, 8, v19
    v_add_u32 v19, 74752, v19
    s_lshr_b32 s81, s86, 1
    s_lshl_b32 s82, s73, 1
    s_add_u32 s81, s81, s82
    s_lshl_b32 s81, s81, 11
    s_and_b32 s82, s86, 1
    s_lshl_b32 s82, s82, 8
    s_add_u32 s85, s81, s82
    v_and_b32 v17, 1, v14
    v_lshrrev_b32 v18, 1, v14
    v_lshlrev_b32 v25, 4, v14
    v_add_u32 v25, 66560, v25
    v_lshlrev_b32 v26, 2, v0
    s_lshl_b32 s84, s75, 6
    s_add_u32 s84, s84, 196608
    s_bitcmp1_b32 s74, 2
    s_cselect_b32 s81, 1024, 0
    s_add_u32 s81, s81, s85
    v_lshlrev_b32 v27, 9, v14
    v_lshl_add_u32 v27, v16, 4, v27
    v_mov_b32 v28, -1
    v_mov_b32 v29, -1
    v_mov_b32 v30, -1
    v_mov_b32 v31, -1
    s_mov_b32 exec_hi, 0
    buffer_store_dwordx4 v[28:31], v27, s[56:59], s81 offen sc1
    s_mov_b32 exec_lo, 0xffff
    buffer_store_dword v28, v26, s[56:59], s84 offen sc1
    s_mov_b64 exec, -1
    s_waitcnt vmcnt(34)
    s_barrier
    s_getreg_b32 s81, hwreg(HW_REG_XCC_ID)
    v_mov_b32 v53, s81
    ds_read_b128 v[192:195], v25 offset:0
    ds_read_b128 v[196:199], v25 offset:64
    ds_read_b128 v[200:203], v25 offset:128
    ds_read_b128 v[204:207], v25 offset:192
    ds_read_b128 v[208:211], v25 offset:256
    ds_read_b128 v[212:215], v25 offset:320
    ds_read_b128 v[216:219], v25 offset:384
    ds_read_b128 v[220:223], v25 offset:448
    ds_read_b128 v[224:227], v25 offset:512
    ds_read_b128 v[228:231], v25 offset:576
    ds_read_b128 v[232:235], v25 offset:640
    ds_read_b128 v[236:239], v25 offset:704
    ds_read_b128 v[240:243], v25 offset:768
    ds_read_b128 v[244:247], v25 offset:832
    ds_read_b128 v[248:251], v25 offset:896
    ds_read_b128 v[252:255], v25 offset:960
    s_bitcmp1_b32 s74, 2
    s_cbranch_scc1 L_job_v
    v_lshlrev_b32 v20, 9, v17
    v_lshl_add_u32 v17, v16, 4, v20
    s_waitcnt vmcnt(18)
    buffer_load_dword v52, off, s[64:67], 0 sc1
    ds_read_b128 v[64:67], v15 offset:0
    ds_read_b128 v[68:71], v15 offset:64
    ds_read_b128 v[72:75], v15 offset:128
    ds_read_b128 v[76:79], v15 offset:192
    ds_read_b128 v[80:83], v15 offset:256
    ds_read_b128 v[84:87], v15 offset:320
    ds_read_b128 v[88:91], v15 offset:384
    ds_read_b128 v[92:95], v15 offset:448
    ds_read_b128 v[96:99], v15 offset:512
    ds_read_b128 v[100:103], v15 offset:576
    ds_read_b128 v[104:107], v15 offset:640
    ds_read_b128 v[108:111], v15 offset:704
    ds_read_b128 v[112:115], v15 offset:768
    ds_read_b128 v[116:119], v15 offset:832
    ds_read_b128 v[120:123], v15 offset:896
    ds_read_b128 v[124:127], v15 offset:960
    s_waitcnt vmcnt(15)
    ds_read_b64_tr_b16 v[128:129], v19 offset:0
    ds_read_b64_tr_b16 v[130:131], v19 offset:128
    ds_read_b64_tr_b16 v[132:133], v19 offset:1024
    ds_read_b64_tr_b16 v[134:135], v19 offset:1152
    ds_read_b64_tr_b16 v[136:137], v19 offset:2048
    ds_read_b64_tr_b16 v[138:139], v19 offset:2176
    ds_read_b64_tr_b16 v[140:141], v19 offset:3072
    ds_read_b64_tr_b16 v[142:143], v19 offset:3200
    s_waitcnt vmcnt(11)
    ds_read_b64_tr_b16 v[144:145], v19 offset:4096
    ds_read_b64_tr_b16 v[146:147], v19 offset:4224
    ds_read_b64_tr_b16 v[148:149], v19 offset:5120
    ds_read_b64_tr_b16 v[150:151], v19 offset:5248
    ds_read_b64_tr_b16 v[152:153], v19 offset:6144
    ds_read_b64_tr_b16 v[154:155], v19 offset:6272
    ds_read_b64_tr_b16 v[156:157], v19 offset:7168
    ds_read_b64_tr_b16 v[158:159], v19 offset:7296
    s_waitcnt lgkmcnt(8)
    v_mfma_f32_16x16x32_bf16 v[44:47], v[128:131], v[64:67], 0
    v_mfma_f32_16x16x32_bf16 v[44:47], v[132:135], v[68:71], v[44:47]
    v_mfma_f32_16x16x32_bf16 v[44:47], v[136:139], v[72:75], v[44:47]
    v_mfma_f32_16x16x32_bf16 v[44:47], v[140:143], v[76:79], v[44:47]
    v_mfma_f32_16x16x32_bf16 v[48:51], v[192:195], v[64:67], 0
    v_mfma_f32_16x16x32_bf16 v[48:51], v[196:199], v[68:71], v[48:51]
    v_mfma_f32_16x16x32_bf16 v[48:51], v[200:203], v[72:75], v[48:51]
    v_mfma_f32_16x16x32_bf16 v[48:51], v[204:207], v[76:79], v[48:51]
    v_mfma_f32_16x16x32_bf16 v[48:51], v[208:211], v[80:83], v[48:51]
    v_mfma_f32_16x16x32_bf16 v[48:51], v[212:215], v[84:87], v[48:51]
    v_mfma_f32_16x16x32_bf16 v[48:51], v[216:219], v[88:91], v[48:51]
    v_mfma_f32_16x16x32_bf16 v[48:51], v[220:223], v[92:95], v[48:51]
    s_waitcnt vmcnt(7)
    ds_read_b64_tr_b16 v[160:161], v19 offset:8192
    ds_read_b64_tr_b16 v[162:163], v19 offset:8320
    ds_read_b64_tr_b16 v[164:165], v19 offset:9216
    ds_read_b64_tr_b16 v[166:167], v19 offset:9344
    ds_read_b64_tr_b16 v[168:169], v19 offset:10240
    ds_read_b64_tr_b16 v[170:171], v19 offset:10368
    ds_read_b64_tr_b16 v[172:173], v19 offset:11264
    ds_read_b64_tr_b16 v[174:175], v19 offset:11392
    s_waitcnt lgkmcnt(8)
    v_mfma_f32_16x16x32_bf16 v[44:47], v[144:147], v[80:83], v[44:47]
    v_mfma_f32_16x16x32_bf16 v[44:47], v[148:151], v[84:87], v[44:47]
    v_mfma_f32_16x16x32_bf16 v[44:47], v[152:155], v[88:91], v[44:47]
    v_mfma_f32_16x16x32_bf16 v[44:47], v[156:159], v[92:95], v[44:47]
    v_mfma_f32_16x16x32_bf16 v[48:51], v[224:227], v[96:99], v[48:51]
    v_mfma_f32_16x16x32_bf16 v[48:51], v[228:231], v[100:103], v[48:51]
    v_mfma_f32_16x16x32_bf16 v[48:51], v[232:235], v[104:107], v[48:51]
    v_mfma_f32_16x16x32_bf16 v[48:51], v[236:239], v[108:111], v[48:51]
    v_mfma_f32_16x16x32_bf16 v[48:51], v[240:243], v[112:115], v[48:51]
    v_mfma_f32_16x16x32_bf16 v[48:51], v[244:247], v[116:119], v[48:51]
    v_mfma_f32_16x16x32_bf16 v[48:51], v[248:251], v[120:123], v[48:51]
    v_mfma_f32_16x16x32_bf16 v[48:51], v[252:255], v[124:127], v[48:51]
    s_waitcnt vmcnt(3)
    ds_read_b64_tr_b16 v[176:177], v19 offset:12288
    ds_read_b64_tr_b16 v[178:179], v19 offset:12416
    ds_read_b64_tr_b16 v[180:181], v19 offset:13312
    ds_read_b64_tr_b16 v[182:183], v19 offset:13440
    ds_read_b64_tr_b16 v[184:185], v19 offset:14336
    ds_read_b64_tr_b16 v[186:187], v19 offset:14464
    ds_read_b64_tr_b16 v[188:189], v19 offset:15360
    ds_read_b64_tr_b16 v[190:191], v19 offset:15488
    s_waitcnt lgkmcnt(8)
    v_mfma_f32_16x16x32_bf16 v[44:47], v[160:163], v[96:99], v[44:47]
    v_mfma_f32_16x16x32_bf16 v[44:47], v[164:167], v[100:103], v[44:47]
    v_mfma_f32_16x16x32_bf16 v[44:47], v[168:171], v[104:107], v[44:47]
    v_mfma_f32_16x16x32_bf16 v[44:47], v[172:175], v[108:111], v[44:47]
    s_waitcnt lgkmcnt(0)
    v_mfma_f32_16x16x32_bf16 v[44:47], v[176:179], v[112:115], v[44:47]
    v_mfma_f32_16x16x32_bf16 v[44:47], v[180:183], v[116:119], v[44:47]
    v_mfma_f32_16x16x32_bf16 v[44:47], v[184:187], v[120:123], v[44:47]
    v_mfma_f32_16x16x32_bf16 v[44:47], v[188:191], v[124:127], v[44:47]
    v_mul_f32 v48, 0xbfb8aa3b, v48
    v_exp_f32 v48, v48
    s_nop 0
    v_add_f32 v48, 1.0, v48
    v_rcp_f32 v48, v48
    s_nop 2
    v_cvt_pk_bf16_f32 v20, v44, v45
    v_cvt_pk_bf16_f32 v21, v46, v47
    v_min_u32 v20, -2, v20
    v_min_u32 v48, -2, v48
    s_nop 0
    v_permlane32_swap_b32 v20, v22
    v_permlane32_swap_b32 v21, v23
    s_mov_b32 exec_hi, 0
    s_branch L_job_st
L_job_v:
    v_lshlrev_b32 v20, 9, v18
    v_lshl_add_u32 v17, v16, 4, v20
    s_add_u32 s85, s85, 1024
    s_waitcnt vmcnt(18)
    buffer_load_dword v52, off, s[64:67], 0 sc1
    ds_read_b128 v[64:67], v15 offset:0
    ds_read_b128 v[68:71], v15 offset:64
    ds_read_b128 v[72:75], v15 offset:128
    ds_read_b128 v[76:79], v15 offset:192
    ds_read_b128 v[80:83], v15 offset:256
    ds_read_b128 v[84:87], v15 offset:320
    ds_read_b128 v[88:91], v15 offset:384
    ds_read_b128 v[92:95], v15 offset:448
    ds_read_b128 v[96:99], v15 offset:512
    ds_read_b128 v[100:103], v15 offset:576
    ds_read_b128 v[104:107], v15 offset:640
    ds_read_b128 v[108:111], v15 offset:704
    ds_read_b128 v[112:115], v15 offset:768
    ds_read_b128 v[116:119], v15 offset:832
    ds_read_b128 v[120:123], v15 offset:896
    ds_read_b128 v[124:127], v15 offset:960
    s_waitcnt vmcnt(15)
    ds_read_b64_tr_b16 v[128:129], v19 offset:0
    ds_read_b64_tr_b16 v[130:131], v19 offset:128
    ds_read_b64_tr_b16 v[132:133], v19 offset:1024
    ds_read_b64_tr_b16 v[134:135], v19 offset:1152
    ds_read_b64_tr_b16 v[136:137], v19 offset:2048
    ds_read_b64_tr_b16 v[138:139], v19 offset:2176
    ds_read_b64_tr_b16 v[140:141], v19 offset:3072
    ds_read_b64_tr_b16 v[142:143], v19 offset:3200
    s_waitcnt vmcnt(11)
    ds_read_b64_tr_b16 v[144:145], v19 offset:4096
    ds_read_b64_tr_b16 v[146:147], v19 offset:4224
    ds_read_b64_tr_b16 v[148:149], v19 offset:5120
    ds_read_b64_tr_b16 v[150:151], v19 offset:5248
    ds_read_b64_tr_b16 v[152:153], v19 offset:6144
    ds_read_b64_tr_b16 v[154:155], v19 offset:6272
    ds_read_b64_tr_b16 v[156:157], v19 offset:7168
    ds_read_b64_tr_b16 v[158:159], v19 offset:7296
    s_waitcnt lgkmcnt(8)
    v_mfma_f32_16x16x32_bf16 v[44:47], v[64:67], v[128:131], 0
    v_mfma_f32_16x16x32_bf16 v[44:47], v[68:71], v[132:135], v[44:47]
    v_mfma_f32_16x16x32_bf16 v[44:47], v[72:75], v[136:139], v[44:47]
    v_mfma_f32_16x16x32_bf16 v[44:47], v[76:79], v[140:143], v[44:47]
    v_mfma_f32_16x16x32_bf16 v[48:51], v[192:195], v[64:67], 0
    v_mfma_f32_16x16x32_bf16 v[48:51], v[196:199], v[68:71], v[48:51]
    v_mfma_f32_16x16x32_bf16 v[48:51], v[200:203], v[72:75], v[48:51]
    v_mfma_f32_16x16x32_bf16 v[48:51], v[204:207], v[76:79], v[48:51]
    v_mfma_f32_16x16x32_bf16 v[48:51], v[208:211], v[80:83], v[48:51]
    v_mfma_f32_16x16x32_bf16 v[48:51], v[212:215], v[84:87], v[48:51]
    v_mfma_f32_16x16x32_bf16 v[48:51], v[216:219], v[88:91], v[48:51]
    v_mfma_f32_16x16x32_bf16 v[48:51], v[220:223], v[92:95], v[48:51]
    s_waitcnt vmcnt(7)
    ds_read_b64_tr_b16 v[160:161], v19 offset:8192
    ds_read_b64_tr_b16 v[162:163], v19 offset:8320
    ds_read_b64_tr_b16 v[164:165], v19 offset:9216
    ds_read_b64_tr_b16 v[166:167], v19 offset:9344
    ds_read_b64_tr_b16 v[168:169], v19 offset:10240
    ds_read_b64_tr_b16 v[170:171], v19 offset:10368
    ds_read_b64_tr_b16 v[172:173], v19 offset:11264
    ds_read_b64_tr_b16 v[174:175], v19 offset:11392
    s_waitcnt lgkmcnt(8)
    v_mfma_f32_16x16x32_bf16 v[44:47], v[80:83], v[144:147], v[44:47]
    v_mfma_f32_16x16x32_bf16 v[44:47], v[84:87], v[148:151], v[44:47]
    v_mfma_f32_16x16x32_bf16 v[44:47], v[88:91], v[152:155], v[44:47]
    v_mfma_f32_16x16x32_bf16 v[44:47], v[92:95], v[156:159], v[44:47]
    v_mfma_f32_16x16x32_bf16 v[48:51], v[224:227], v[96:99], v[48:51]
    v_mfma_f32_16x16x32_bf16 v[48:51], v[228:231], v[100:103], v[48:51]
    v_mfma_f32_16x16x32_bf16 v[48:51], v[232:235], v[104:107], v[48:51]
    v_mfma_f32_16x16x32_bf16 v[48:51], v[236:239], v[108:111], v[48:51]
    v_mfma_f32_16x16x32_bf16 v[48:51], v[240:243], v[112:115], v[48:51]
    v_mfma_f32_16x16x32_bf16 v[48:51], v[244:247], v[116:119], v[48:51]
    v_mfma_f32_16x16x32_bf16 v[48:51], v[248:251], v[120:123], v[48:51]
    v_mfma_f32_16x16x32_bf16 v[48:51], v[252:255], v[124:127], v[48:51]
    s_waitcnt vmcnt(3)
    ds_read_b64_tr_b16 v[176:177], v19 offset:12288
    ds_read_b64_tr_b16 v[178:179], v19 offset:12416
    ds_read_b64_tr_b16 v[180:181], v19 offset:13312
    ds_read_b64_tr_b16 v[182:183], v19 offset:13440
    ds_read_b64_tr_b16 v[184:185], v19 offset:14336
    ds_read_b64_tr_b16 v[186:187], v19 offset:14464
    ds_read_b64_tr_b16 v[188:189], v19 offset:15360
    ds_read_b64_tr_b16 v[190:191], v19 offset:15488
    s_waitcnt lgkmcnt(8)
    v_mfma_f32_16x16x32_bf16 v[44:47], v[96:99], v[160:163], v[44:47]
    v_mfma_f32_16x16x32_bf16 v[44:47], v[100:103], v[164:167], v[44:47]
    v_mfma_f32_16x16x32_bf16 v[44:47], v[104:107], v[168:171], v[44:47]
    v_mfma_f32_16x16x32_bf16 v[44:47], v[108:111], v[172:175], v[44:47]
    s_waitcnt lgkmcnt(0)
    v_mfma_f32_16x16x32_bf16 v[44:47], v[112:115], v[176:179], v[44:47]
    v_mfma_f32_16x16x32_bf16 v[44:47], v[116:119], v[180:183], v[44:47]
    v_mfma_f32_16x16x32_bf16 v[44:47], v[120:123], v[184:187], v[44:47]
    v_mfma_f32_16x16x32_bf16 v[44:47], v[124:127], v[188:191], v[44:47]
    v_mul_f32 v48, 0xbfb8aa3b, v48
    v_exp_f32 v48, v48
    s_nop 0
    v_add_f32 v48, 1.0, v48
    v_rcp_f32 v48, v48
    s_nop 2
    v_cvt_pk_bf16_f32 v20, v44, v45
    v_cvt_pk_bf16_f32 v21, v46, v47
    v_min_u32 v20, -2, v20
    v_min_u32 v48, -2, v48
    s_nop 0
    v_permlane16_swap_b32 v20, v22
    v_permlane16_swap_b32 v21, v23
    s_mov_b32 exec_lo, 0xffff
    s_mov_b32 exec_hi, 0xffff
L_job_st:
    s_waitcnt vmcnt(0)
    buffer_store_dwordx4 v[20:23], v17, s[56:59], s85 offen sc1
    s_mov_b64 exec, 0xffff
    buffer_store_dword v48, v26, s[56:59], s84 offen sc1
    s_mov_b64 exec, -1
    s_lshl_b32 s81, s73, 7
    s_lshl_b32 s82, s74, 3
    s_add_u32 s81, s81, s82
    s_add_u32 s81, s81, 524288
    v_cmp_eq_u32 vcc, 0, v52
    s_cbranch_vccnz Lnp_1
Lnpd_2:
    s_mov_b32 exec_lo, 0x1
    s_mov_b32 exec_hi, 0
    buffer_store_dwordx2 v[52:53], v26, s[56:59], s81 offen sc1
    s_mov_b64 exec, -1
    v_mov_b32 v13, 160768
    ds_write_b32 v13, v52
    s_waitcnt lgkmcnt(0)
    s_branch L_aw03
.p2align 12
L_aw12:
    s_lshl_b32 s75, s73, 3
    s_add_u32 s75, s75, s74
    s_mov_b32 s77, 400000
    s_lshl_b32 s92, s75, 7
    s_add_u32 s92, s92, 524288
    v_lshrrev_b32 v11, 3, v0
    v_and_b32 v12, 7, v0
    v_lshrrev_b32 v13, 2, v0
    v_and_b32 v13, 4, v13
    v_xor_b32 v12, v12, v13
    v_lshlrev_b32 v12, 4, v12
    v_lshl_add_u32 v9, v11, 10, v12
    v_mul_u32_u24 v8, 3072, v11
    v_add_u32 v8, v8, v12
    v_mov_b32 v11, v9
    s_lshr_b32 s78, s72, 1
    s_lshl_b32 s79, s78, 13
    s_lshl_b32 s87, s78, 16
    s_lshl_b32 s83, s74, 7
    s_add_u32 s87, s87, s83
    s_mul_i32 s80, s78, 3
    s_lshl_b32 s81, s86, 1
    s_add_u32 s80, s80, s81
    s_add_u32 s80, s80, 2
    v_mov_b32 v9, 160768
    v_mov_b32 v8, 1
    s_waitcnt lgkmcnt(0)
    s_mov_b32 s32, s4
    s_mov_b32 s33, s5
    s_mov_b32 s34, 0x200000
    s_mov_b32 s35, 0x20000
    s_mov_b32 s36, s6
    s_mov_b32 s37, s7
    s_mov_b32 s38, 0x80000
    s_mov_b32 s39, 0x20000
    s_mov_b32 s56, s28
    s_mov_b32 s57, s29
    s_mov_b32 s58, 0x800000
    s_mov_b32 s59, 0x20000
    v_and_b32 v12, 15, v0
    v_cmp_eq_u32 vcc, 0, v12
    v_mov_b32 v13, 0x3f803f80
    s_nop 0
    v_cndmask_b32 v12, 0, v13, vcc
    v_cndmask_b32 v13, 0, v13, vcc
    v_mov_b64 v[132:133], v[12:13]
    v_mov_b64 v[134:135], v[12:13]
    v_mov_b64 v[140:141], v[12:13]
    v_mov_b64 v[142:143], v[12:13]
    v_mov_b64 v[148:149], v[12:13]
    v_mov_b64 v[150:151], v[12:13]
    v_mov_b64 v[156:157], v[12:13]
    v_mov_b64 v[158:159], v[12:13]
    v_mov_b64 v[164:165], v[12:13]
    v_mov_b64 v[166:167], v[12:13]
    v_mov_b64 v[172:173], v[12:13]
    v_mov_b64 v[174:175], v[12:13]
    v_mov_b64 v[180:181], v[12:13]
    v_mov_b64 v[182:183], v[12:13]
    v_mov_b64 v[188:189], v[12:13]
    v_mov_b64 v[190:191], v[12:13]
    v_mov_b64 v[196:197], v[12:13]
    v_mov_b64 v[198:199], v[12:13]
    v_mov_b64 v[204:205], v[12:13]
    v_mov_b64 v[206:207], v[12:13]
    v_mov_b64 v[212:213], v[12:13]
    v_mov_b64 v[214:215], v[12:13]
    v_mov_b64 v[220:221], v[12:13]
    v_mov_b64 v[222:223], v[12:13]
    v_mov_b64 v[228:229], v[12:13]
    v_mov_b64 v[230:231], v[12:13]
    v_mov_b64 v[236:237], v[12:13]
    v_mov_b64 v[238:239], v[12:13]
    v_mov_b64 v[244:245], v[12:13]
    v_mov_b64 v[246:247], v[12:13]
    v_mov_b64 v[252:253], v[12:13]
    v_mov_b64 v[254:255], v[12:13]
    s_add_u32 s81, s80, 0
    s_and_b32 s81, s81, 7
    s_lshl_b32 s94, s73, 16
    s_lshl_b32 s83, s81, 13
    s_add_u32 s94, s94, s83
    s_mul_i32 s93, s81, 8320
    s_barrier
    s_add_u32 m0, s93, 0
    s_nop 0
    buffer_load_dwordx4 v10, s[32:35], s94 offen offset:0  lds
    s_add_u32 m0, s93, 16
    s_nop 0
    buffer_load_dwordx4 v10, s[32:35], s94 offen offset:1024  lds
    s_add_u32 m0, s93, 32
    s_nop 0
    buffer_load_dwordx4 v10, s[32:35], s94 offen offset:2048  lds
    s_add_u32 m0, s93, 48
    s_nop 0
    buffer_load_dwordx4 v10, s[32:35], s94 offen offset:3072  lds
    s_add_u32 m0, s93, 4160
    s_add_u32 s94, s94, 4096
    buffer_load_dwordx4 v10, s[32:35], s94 offen offset:0  lds
    s_add_u32 m0, s93, 4176
    s_nop 0
    buffer_load_dwordx4 v10, s[32:35], s94 offen offset:1024  lds
    s_add_u32 m0, s93, 4192
    s_nop 0
    buffer_load_dwordx4 v10, s[32:35], s94 offen offset:2048  lds
    s_add_u32 m0, s93, 4208
    s_nop 0
    buffer_load_dwordx4 v10, s[32:35], s94 offen offset:3072  lds
    s_add_u32 s81, s80, 1
    s_and_b32 s81, s81, 7
    s_lshl_b32 s94, s73, 16
    s_lshl_b32 s83, s81, 13
    s_add_u32 s94, s94, s83
    s_mul_i32 s93, s81, 8320
    s_add_u32 m0, s93, 0
    s_nop 0
    buffer_load_dwordx4 v10, s[32:35], s94 offen offset:0  lds
    s_add_u32 m0, s93, 16
    s_nop 0
    buffer_load_dwordx4 v10, s[32:35], s94 offen offset:1024  lds
    s_add_u32 m0, s93, 32
    s_nop 0
    buffer_load_dwordx4 v10, s[32:35], s94 offen offset:2048  lds
    s_add_u32 m0, s93, 48
    s_nop 0
    buffer_load_dwordx4 v10, s[32:35], s94 offen offset:3072  lds
    s_add_u32 m0, s93, 4160
    s_add_u32 s94, s94, 4096
    buffer_load_dwordx4 v10, s[32:35], s94 offen offset:0  lds
    s_add_u32 m0, s93, 4176
    s_nop 0
    buffer_load_dwordx4 v10, s[32:35], s94 offen offset:1024  lds
    s_add_u32 m0, s93, 4192
    s_nop 0
    buffer_load_dwordx4 v10, s[32:35], s94 offen offset:2048  lds
    s_add_u32 m0, s93, 4208
    s_nop 0
    buffer_load_dwordx4 v10, s[32:35], s94 offen offset:3072  lds
    s_add_u32 s81, s80, 2
    s_and_b32 s81, s81, 7
    s_lshl_b32 s94, s73, 16
    s_lshl_b32 s83, s81, 13
    s_add_u32 s94, s94, s83
    s_mul_i32 s93, s81, 8320
    s_add_u32 m0, s93, 0
    s_nop 0
    buffer_load_dwordx4 v10, s[32:35], s94 offen offset:0  lds
    s_add_u32 m0, s93, 16
    s_nop 0
    buffer_load_dwordx4 v10, s[32:35], s94 offen offset:1024  lds
    s_add_u32 m0, s93, 32
    s_nop 0
    buffer_load_dwordx4 v10, s[32:35], s94 offen offset:2048  lds
    s_add_u32 m0, s93, 48
    s_nop 0
    buffer_load_dwordx4 v10, s[32:35], s94 offen offset:3072  lds
    s_add_u32 m0, s93, 4160
    s_add_u32 s94, s94, 4096
    buffer_load_dwordx4 v10, s[32:35], s94 offen offset:0  lds
    s_add_u32 m0, s93, 4176
    s_nop 0
    buffer_load_dwordx4 v10, s[32:35], s94 offen offset:1024  lds
    s_add_u32 m0, s93, 4192
    s_nop 0
    buffer_load_dwordx4 v10, s[32:35], s94 offen offset:2048  lds
    s_add_u32 m0, s93, 4208
    s_nop 0
    buffer_load_dwordx4 v10, s[32:35], s94 offen offset:3072  lds
    s_add_u32 m0, s79, 107520
    s_add_u32 s82, s87, 0
    buffer_load_dwordx4 v11, s[36:39], s82 offen lds
    s_add_u32 m0, s79, 108544
    s_add_u32 s82, s87, 8192
    buffer_load_dwordx4 v11, s[36:39], s82 offen lds
    s_add_u32 m0, s79, 109568
    s_add_u32 s82, s87, 16384
    buffer_load_dwordx4 v11, s[36:39], s82 offen lds
    s_add_u32 m0, s79, 110592
    s_add_u32 s82, s87, 24576
    buffer_load_dwordx4 v11, s[36:39], s82 offen lds
    s_add_u32 m0, s79, 111616
    s_add_u32 s82, s87, 32768
    buffer_load_dwordx4 v11, s[36:39], s82 offen lds
    s_add_u32 m0, s79, 112640
    s_add_u32 s82, s87, 40960
    buffer_load_dwordx4 v11, s[36:39], s82 offen lds
    s_add_u32 m0, s79, 113664
    s_add_u32 s82, s87, 49152
    buffer_load_dwordx4 v11, s[36:39], s82 offen lds
    s_add_u32 m0, s79, 114688
    s_add_u32 s82, s87, 57344
    buffer_load_dwordx4 v11, s[36:39], s82 offen lds
    s_add_u32 m0, s79, 123904
    s_add_u32 s82, s87, 131072
    buffer_load_dwordx4 v11, s[36:39], s82 offen lds
    s_add_u32 m0, s79, 124928
    s_add_u32 s82, s87, 139264
    buffer_load_dwordx4 v11, s[36:39], s82 offen lds
    s_add_u32 m0, s79, 125952
    s_add_u32 s82, s87, 147456
    buffer_load_dwordx4 v11, s[36:39], s82 offen lds
    s_add_u32 m0, s79, 126976
    s_add_u32 s82, s87, 155648
    buffer_load_dwordx4 v11, s[36:39], s82 offen lds
    s_add_u32 m0, s79, 128000
    s_add_u32 s82, s87, 163840
    buffer_load_dwordx4 v11, s[36:39], s82 offen lds
    s_add_u32 m0, s79, 129024
    s_add_u32 s82, s87, 172032
    buffer_load_dwordx4 v11, s[36:39], s82 offen lds
    s_add_u32 m0, s79, 130048
    s_add_u32 s82, s87, 180224
    buffer_load_dwordx4 v11, s[36:39], s82 offen lds
    s_add_u32 m0, s79, 131072
    s_add_u32 s82, s87, 188416
    buffer_load_dwordx4 v11, s[36:39], s82 offen lds
    s_waitcnt vmcnt(16)
    s_barrier
    s_waitcnt vmcnt(8)
    s_mov_b64 exec, 1
    ds_add_u32 v9, v8 offset:72
    s_mov_b64 exec, -1
    s_waitcnt vmcnt(0)
    s_mov_b64 exec, 1
    ds_add_u32 v9, v8 offset:76
    s_mov_b64 exec, -1
Law_3:
    ds_read_b32 v14, v9 offset:80
    s_waitcnt lgkmcnt(0)
    v_cmp_gt_u32 vcc, 1, v14
    s_cbranch_vccz Lawd_4
    s_cmp_eq_u32 s77, 0
    s_cbranch_scc1 Lawd_4
    s_sub_u32 s77, s77, 1
    s_sleep 1
    s_branch Law_3
Lawd_4:
    s_lshl_b32 s82, s72, 10
    v_lshrrev_b32 v11, 3, v0
    v_lshl_add_u32 v11, v11, 7, s82
    v_and_b32 v14, 7, v0
    v_lshl_add_u32 v11, v14, 3, v11
    s_mov_b32 s81, 524288
    buffer_load_dword v28, v11, s[56:59], s81 offen sc1
    s_branch L_aw_all
L_aw3b:
    v_lshrrev_b32 v11, 3, v0
    v_and_b32 v12, 7, v0
    v_lshrrev_b32 v13, 2, v0
    v_and_b32 v13, 4, v13
    v_xor_b32 v12, v12, v13
    v_lshlrev_b32 v12, 4, v12
    v_lshl_add_u32 v9, v11, 10, v12
    v_mul_u32_u24 v8, 3072, v11
    v_add_u32 v8, v8, v12
    v_mov_b32 v11, v9
    s_lshr_b32 s78, s72, 1
    s_lshl_b32 s79, s78, 13
    s_lshl_b32 s87, s78, 16
    s_lshl_b32 s83, s74, 7
    s_add_u32 s87, s87, s83
    s_mov_b32 s36, s6
    s_mov_b32 s37, s7
    s_mov_b32 s38, 0x80000
    s_mov_b32 s39, 0x20000
    s_lshl_b32 s75, s73, 3
    s_add_u32 s75, s75, s74
    s_mov_b32 s77, 400000
    s_lshl_b32 s92, s75, 7
    s_add_u32 s92, s92, 524288
    s_mov_b32 s56, s28
    s_mov_b32 s57, s29
    s_mov_b32 s58, 0x800000
    s_mov_b32 s59, 0x20000
    v_mov_b32 v24, 0
    v_mov_b32 v25, 0
    v_mov_b32 v26, 0
    v_mov_b32 v27, 0
    v_add_u32 v13, 156672, v10
    ds_write_b128 v13, v[24:27] offset:0
    ds_write_b128 v13, v[24:27] offset:1024
    ds_write_b128 v13, v[24:27] offset:2048
    ds_write_b128 v13, v[24:27] offset:3072
    v_lshlrev_b32 v13, 2, v0
    v_add_u32 v13, 160768, v13
    v_lshrrev_b32 v14, 2, v0
    v_cmp_eq_u32 vcc, 1, v14
    s_nop 1
    v_cndmask_b32 v14, 0, v14, vcc
    ds_write_b32 v13, v14
    s_waitcnt lgkmcnt(0)
    s_barrier
    s_branch L_aw_visit
L_aw_back:
    s_waitcnt vmcnt(0)
L_aw03:
    s_barrier
    s_add_u32 m0, s79, 140288
    s_add_u32 s82, s87, 262144
    buffer_load_dwordx4 v11, s[36:39], s82 offen lds
    s_add_u32 m0, s79, 141312
    s_add_u32 s82, s87, 270336
    buffer_load_dwordx4 v11, s[36:39], s82 offen lds
    s_add_u32 m0, s79, 142336
    s_add_u32 s82, s87, 278528
    buffer_load_dwordx4 v11, s[36:39], s82 offen lds
    s_add_u32 m0, s79, 143360
    s_add_u32 s82, s87, 286720
    buffer_load_dwordx4 v11, s[36:39], s82 offen lds
    s_add_u32 m0, s79, 144384
    s_add_u32 s82, s87, 294912
    buffer_load_dwordx4 v11, s[36:39], s82 offen lds
    s_add_u32 m0, s79, 145408
    s_add_u32 s82, s87, 303104
    buffer_load_dwordx4 v11, s[36:39], s82 offen lds
    s_add_u32 m0, s79, 146432
    s_add_u32 s82, s87, 311296
    buffer_load_dwordx4 v11, s[36:39], s82 offen lds
    s_add_u32 m0, s79, 147456
    s_add_u32 s82, s87, 319488
    buffer_load_dwordx4 v11, s[36:39], s82 offen lds
    s_add_u32 m0, s79, 91136
    s_add_u32 s82, s87, 393216
    buffer_load_dwordx4 v11, s[36:39], s82 offen lds
    s_add_u32 m0, s79, 92160
    s_add_u32 s82, s87, 401408
    buffer_load_dwordx4 v11, s[36:39], s82 offen lds
    s_add_u32 m0, s79, 93184
    s_add_u32 s82, s87, 409600
    buffer_load_dwordx4 v11, s[36:39], s82 offen lds
    s_add_u32 m0, s79, 94208
    s_add_u32 s82, s87, 417792
    buffer_load_dwordx4 v11, s[36:39], s82 offen lds
    s_add_u32 m0, s79, 95232
    s_add_u32 s82, s87, 425984
    buffer_load_dwordx4 v11, s[36:39], s82 offen lds
    s_add_u32 m0, s79, 96256
    s_add_u32 s82, s87, 434176
    buffer_load_dwordx4 v11, s[36:39], s82 offen lds
    s_add_u32 m0, s79, 97280
    s_add_u32 s82, s87, 442368
    buffer_load_dwordx4 v11, s[36:39], s82 offen lds
    s_add_u32 m0, s79, 98304
    s_add_u32 s82, s87, 450560
    buffer_load_dwordx4 v11, s[36:39], s82 offen lds
    v_mov_b32 v9, 160768
    v_mov_b32 v8, 1
    v_and_b32 v12, 15, v0
    v_cmp_eq_u32 vcc, 0, v12
    v_mov_b32 v13, 0x3f803f80
    s_nop 0
    v_cndmask_b32 v12, 0, v13, vcc
    v_cndmask_b32 v13, 0, v13, vcc
    v_mov_b64 v[132:133], v[12:13]
    v_mov_b64 v[134:135], v[12:13]
    v_mov_b64 v[140:141], v[12:13]
    v_mov_b64 v[142:143], v[12:13]
    v_mov_b64 v[148:149], v[12:13]
    v_mov_b64 v[150:151], v[12:13]
    v_mov_b64 v[156:157], v[12:13]
    v_mov_b64 v[158:159], v[12:13]
    v_mov_b64 v[164:165], v[12:13]
    v_mov_b64 v[166:167], v[12:13]
    v_mov_b64 v[172:173], v[12:13]
    v_mov_b64 v[174:175], v[12:13]
    v_mov_b64 v[180:181], v[12:13]
    v_mov_b64 v[182:183], v[12:13]
    v_mov_b64 v[188:189], v[12:13]
    v_mov_b64 v[190:191], v[12:13]
    v_mov_b64 v[196:197], v[12:13]
    v_mov_b64 v[198:199], v[12:13]
    v_mov_b64 v[204:205], v[12:13]
    v_mov_b64 v[206:207], v[12:13]
    v_mov_b64 v[212:213], v[12:13]
    v_mov_b64 v[214:215], v[12:13]
    v_mov_b64 v[220:221], v[12:13]
    v_mov_b64 v[222:223], v[12:13]
    v_mov_b64 v[228:229], v[12:13]
    v_mov_b64 v[230:231], v[12:13]
    v_mov_b64 v[236:237], v[12:13]
    v_mov_b64 v[238:239], v[12:13]
    v_mov_b64 v[244:245], v[12:13]
    v_mov_b64 v[246:247], v[12:13]
    v_mov_b64 v[252:253], v[12:13]
    v_mov_b64 v[254:255], v[12:13]
    s_waitcnt vmcnt(8)
    s_mov_b64 exec, 1
    ds_add_u32 v9, v8 offset:80
    s_mov_b64 exec, -1
    s_lshl_b32 s82, s72, 10
    v_lshrrev_b32 v11, 3, v0
    v_lshl_add_u32 v11, v11, 7, s82
    v_and_b32 v14, 7, v0
    v_lshl_add_u32 v11, v14, 3, v11
    s_mov_b32 s81, 524288
    buffer_load_dword v28, v11, s[56:59], s81 offen sc1
    s_waitcnt vmcnt(1)
    s_mov_b64 exec, 1
    ds_add_u32 v9, v8 offset:84
    s_mov_b64 exec, -1
L_aw_all:
Law_5:
    ds_read_b32 v14, v9 offset:0
    s_waitcnt lgkmcnt(0)
    v_cmp_gt_u32 vcc, 1, v14
    s_cbranch_vccz Lawd_6
    s_cmp_eq_u32 s77, 0
    s_cbranch_scc1 Lawd_6
    s_sub_u32 s77, s77, 1
    s_branch Law_5
Lawd_6:
    s_lshl_b32 s85, s72, 15
    s_lshr_b32 s83, s2, 3
    s_and_b32 s83, s83, 7
    s_lshl_b32 s83, s83, 12
    s_add_u32 s85, s85, s83
    v_readfirstlane_b32 s76, v14
    s_waitcnt vmcnt(0)
    s_nop 0
    v_cmp_ne_u32 vcc, s76, v28
    s_cbranch_vccnz Lpf_7
Lpfd_8:
L_aw_kv:
    s_xor_b32 s84, s85, 0
    buffer_load_dwordx4 v[64:67], v10, s[56:59], s84 offen offset:0 sc1
    buffer_load_dwordx4 v[128:131], v10, s[56:59], s84 offen offset:1024 sc1
    buffer_load_dwordx4 v[68:71], v10, s[56:59], s84 offen offset:2048 sc1
    buffer_load_dwordx4 v[136:139], v10, s[56:59], s84 offen offset:3072 sc1
    s_xor_b32 s84, s85, 4096
    buffer_load_dwordx4 v[72:75], v10, s[56:59], s84 offen offset:0 sc1
    buffer_load_dwordx4 v[144:147], v10, s[56:59], s84 offen offset:1024 sc1
    buffer_load_dwordx4 v[76:79], v10, s[56:59], s84 offen offset:2048 sc1
    buffer_load_dwordx4 v[152:155], v10, s[56:59], s84 offen offset:3072 sc1
    v_mov_b32 v11, 0
    s_lshl_b32 s81, s72, 11
    s_add_u32 s81, s81, 74752
    v_add_u32 v5, s81, v10
    v_add_u32 v4, 66560, v10
    s_lshl_b32 s81, s72, 8
    s_add_u32 s81, s81, 156672
    v_lshl_add_u32 v6, v0, 2, s81
    v_mov_b32 v7, 160784
    v_mov_b32 v1, 0xdddd
    v_mov_b32 v2, 0
    v_mov_b32 v3, 0
    s_movk_i32 s81, 0x3f80
    v_writelane_b32 v2, s81, 20
    s_lshr_b32 s93, s72, 1
    s_lshl_b32 s93, s93, 10
    s_and_b32 s81, s72, 1
    s_lshl_b32 s81, s81, 3
    s_add_u32 s93, s93, s81
    s_add_u32 s93, s93, 99328
    s_lshl_b32 s81, s73, 7
    s_lshl_b32 s82, s74, 2
    s_add_u32 s81, s81, s82
    s_lshl_b32 s94, s81, 10
    s_add_u32 s94, s94, 4262912
    s_mov_b32 s82, 74752
    v_mfma_f32_32x32x8_bf16 v[44:59], v[2:3], v[2:3], 0
    s_mov_b32 s87, 7
    s_branch L_aw_pg
Lnp_1:
    s_cmp_eq_u32 s77, 0
    s_cbranch_scc1 Lnpd_2
    s_sub_u32 s77, s77, 1
    buffer_load_dword v52, off, s[64:67], 0 sc1
    s_waitcnt vmcnt(0)
    v_cmp_eq_u32 vcc, 0, v52
    s_cbranch_vccnz Lnp_1
    s_branch Lnpd_2
Lpf_7:
    s_cmp_eq_u32 s77, 0
    s_cbranch_scc1 Lpfd_8
    s_sub_u32 s77, s77, 1
    s_sleep 2
    s_mov_b64 exec, vcc
    s_mov_b32 s81, 524288
    buffer_load_dword v28, v11, s[56:59], s81 offen sc1
    s_mov_b64 exec, -1
    s_waitcnt vmcnt(0)
    v_cmp_ne_u32 vcc, s76, v28
    s_cbranch_vccnz Lpf_7
    s_branch Lpfd_8
L_aw_redo:
    s_cmp_eq_u32 s77, 0
    s_cbranch_scc1 L_aw_go
    s_sub_u32 s77, s77, 1
    s_nop 15
    s_nop 15
    v_and_b32 v12, 15, v0
    v_cmp_eq_u32 vcc, 0, v12
    v_mov_b32 v13, 0x3f803f80
    s_nop 0
    v_cndmask_b32 v12, 0, v13, vcc
    v_cndmask_b32 v13, 0, v13, vcc
    v_mov_b64 v[132:133], v[12:13]
    v_mov_b64 v[134:135], v[12:13]
    v_mov_b64 v[140:141], v[12:13]
    v_mov_b64 v[142:143], v[12:13]
    v_mov_b64 v[148:149], v[12:13]
    v_mov_b64 v[150:151], v[12:13]
    v_mov_b64 v[156:157], v[12:13]
    v_mov_b64 v[158:159], v[12:13]
    v_mov_b64 v[164:165], v[12:13]
    v_mov_b64 v[166:167], v[12:13]
    v_mov_b64 v[172:173], v[12:13]
    v_mov_b64 v[174:175], v[12:13]
    v_mov_b64 v[180:181], v[12:13]
    v_mov_b64 v[182:183], v[12:13]
    v_mov_b64 v[188:189], v[12:13]
    v_mov_b64 v[190:191], v[12:13]
    v_mov_b64 v[196:197], v[12:13]
    v_mov_b64 v[198:199], v[12:13]
    v_mov_b64 v[204:205], v[12:13]
    v_mov_b64 v[206:207], v[12:13]
    v_mov_b64 v[212:213], v[12:13]
    v_mov_b64 v[214:215], v[12:13]
    v_mov_b64 v[220:221], v[12:13]
    v_mov_b64 v[222:223], v[12:13]
    v_mov_b64 v[228:229], v[12:13]
    v_mov_b64 v[230:231], v[12:13]
    v_mov_b64 v[236:237], v[12:13]
    v_mov_b64 v[238:239], v[12:13]
    v_mov_b64 v[244:245], v[12:13]
    v_mov_b64 v[246:247], v[12:13]
    v_mov_b64 v[252:253], v[12:13]
    v_mov_b64 v[254:255], v[12:13]
    v_mov_b32 v8, 0
    s_mov_b32 s95, 1
    s_branch L_aw_kv
.p2align 12
L_aw_visit:
    s_branch L_aw_visit2
L_aw_pg:
Law_9:
    ds_read_b32 v14, v9 offset:68
    ds_read_b128 v[60:63], v4
    s_waitcnt lgkmcnt(0)
    v_cmp_gt_u32 vcc, 4, v14
    s_cbranch_vccz Lawd_10
    s_cmp_eq_u32 s77, 0
    s_cbranch_scc1 Lawd_10
    s_sub_u32 s77, s77, 1
    s_sleep 1
    s_branch Law_9
Lawd_10:
    s_setprio 1
    s_waitcnt vmcnt(7)
    v_mfma_f32_32x32x16_bf16 v[12:27], v[64:67], v[60:63], 0
    s_nop 11
    v_exp_f32 v12, v12
    v_exp_f32 v13, v13
    v_exp_f32 v14, v14
    v_exp_f32 v15, v15
    v_exp_f32 v16, v16
    s_waitcnt vmcnt(5)
    v_mfma_f32_32x32x16_bf16 v[28:43], v[68:71], v[60:63], 0
    v_exp_f32 v17, v17
    v_exp_f32 v18, v18
    v_exp_f32 v19, v19
    v_max3_u32 v11, v11, v64, v128
    v_permlane16_swap_b32 v128, v132
    v_permlane16_swap_b32 v129, v133
    v_permlane16_swap_b32 v130, v134
    v_permlane16_swap_b32 v131, v135
    s_xor_b32 s84, s85, 8192
    buffer_load_dwordx4 v[80:83], v10, s[56:59], s84 offen offset:0 sc1
    buffer_load_dwordx4 v[160:163], v10, s[56:59], s84 offen offset:1024 sc1
    buffer_load_dwordx4 v[84:87], v10, s[56:59], s84 offen offset:2048 sc1
    buffer_load_dwordx4 v[168:171], v10, s[56:59], s84 offen offset:3072 sc1
    v_exp_f32 v20, v20
    v_exp_f32 v21, v21
    v_exp_f32 v22, v22
    v_exp_f32 v23, v23
    v_exp_f32 v24, v24
    v_exp_f32 v25, v25
    v_exp_f32 v26, v26
    v_smfmac_f32_32x32x32_bf16 v[44:59], v[128:131], v[12:19], v1
    v_exp_f32 v27, v27
    v_exp_f32 v28, v28
    v_exp_f32 v29, v29
    v_smfmac_f32_32x32x32_bf16 v[44:59], v[132:135], v[20:27], v1
    v_exp_f32 v30, v30
    v_exp_f32 v31, v31
    v_exp_f32 v32, v32
    s_waitcnt vmcnt(7)
    v_mfma_f32_32x32x16_bf16 v[12:27], v[72:75], v[60:63], 0
    v_exp_f32 v33, v33
    v_exp_f32 v34, v34
    v_exp_f32 v35, v35
    v_max3_u32 v11, v11, v68, v136
    v_permlane16_swap_b32 v136, v140
    v_permlane16_swap_b32 v137, v141
    v_permlane16_swap_b32 v138, v142
    v_permlane16_swap_b32 v139, v143
    s_xor_b32 s84, s85, 12288
    buffer_load_dwordx4 v[88:91], v10, s[56:59], s84 offen offset:0 sc1
    buffer_load_dwordx4 v[176:179], v10, s[56:59], s84 offen offset:1024 sc1
    buffer_load_dwordx4 v[92:95], v10, s[56:59], s84 offen offset:2048 sc1
    buffer_load_dwordx4 v[184:187], v10, s[56:59], s84 offen offset:3072 sc1
    v_exp_f32 v36, v36
    v_exp_f32 v37, v37
    v_exp_f32 v38, v38
    v_exp_f32 v39, v39
    v_exp_f32 v40, v40
    v_exp_f32 v41, v41
    v_exp_f32 v42, v42
    v_smfmac_f32_32x32x32_bf16 v[44:59], v[136:139], v[28:35], v1
    v_exp_f32 v43, v43
    v_exp_f32 v12, v12
    v_exp_f32 v13, v13
    v_smfmac_f32_32x32x32_bf16 v[44:59], v[140:143], v[36:43], v1
    v_exp_f32 v14, v14
    v_exp_f32 v15, v15
    v_exp_f32 v16, v16
    s_waitcnt vmcnt(9)
    v_mfma_f32_32x32x16_bf16 v[28:43], v[76:79], v[60:63], 0
    v_exp_f32 v17, v17
    v_exp_f32 v18, v18
    v_exp_f32 v19, v19
    v_max3_u32 v11, v11, v72, v144
    v_permlane16_swap_b32 v144, v148
    v_permlane16_swap_b32 v145, v149
    v_permlane16_swap_b32 v146, v150
    v_permlane16_swap_b32 v147, v151
    s_xor_b32 s84, s85, 16384
    buffer_load_dwordx4 v[96:99], v10, s[56:59], s84 offen offset:0 sc1
    buffer_load_dwordx4 v[192:195], v10, s[56:59], s84 offen offset:1024 sc1
    buffer_load_dwordx4 v[100:103], v10, s[56:59], s84 offen offset:2048 sc1
    buffer_load_dwordx4 v[200:203], v10, s[56:59], s84 offen offset:3072 sc1
    v_exp_f32 v20, v20
    v_exp_f32 v21, v21
    v_exp_f32 v22, v22
    v_exp_f32 v23, v23
    v_exp_f32 v24, v24
    v_exp_f32 v25, v25
    v_exp_f32 v26, v26
    v_smfmac_f32_32x32x32_bf16 v[44:59], v[144:147], v[12:19], v1
    v_exp_f32 v27, v27
    v_exp_f32 v28, v28
    v_exp_f32 v29, v29
    v_smfmac_f32_32x32x32_bf16 v[44:59], v[148:151], v[20:27], v1
    v_exp_f32 v30, v30
    v_exp_f32 v31, v31
    v_exp_f32 v32, v32
    s_waitcnt vmcnt(11)
    v_mfma_f32_32x32x16_bf16 v[12:27], v[80:83], v[60:63], 0
    v_exp_f32 v33, v33
    v_exp_f32 v34, v34
    v_exp_f32 v35, v35
    v_max3_u32 v11, v11, v76, v152
    v_permlane16_swap_b32 v152, v156
    v_permlane16_swap_b32 v153, v157
    v_permlane16_swap_b32 v154, v158
    v_permlane16_swap_b32 v155, v159
    s_xor_b32 s84, s85, 20480
    buffer_load_dwordx4 v[104:107], v10, s[56:59], s84 offen offset:0 sc1
    buffer_load_dwordx4 v[208:211], v10, s[56:59], s84 offen offset:1024 sc1
    buffer_load_dwordx4 v[108:111], v10, s[56:59], s84 offen offset:2048 sc1
    buffer_load_dwordx4 v[216:219], v10, s[56:59], s84 offen offset:3072 sc1
    v_exp_f32 v36, v36
    v_exp_f32 v37, v37
    v_exp_f32 v38, v38
    v_exp_f32 v39, v39
    v_exp_f32 v40, v40
    v_exp_f32 v41, v41
    v_exp_f32 v42, v42
    v_smfmac_f32_32x32x32_bf16 v[44:59], v[152:155], v[28:35], v1
    v_exp_f32 v43, v43
    v_exp_f32 v12, v12
    v_exp_f32 v13, v13
    v_smfmac_f32_32x32x32_bf16 v[44:59], v[156:159], v[36:43], v1
    v_exp_f32 v14, v14
    v_exp_f32 v15, v15
    v_exp_f32 v16, v16
    s_waitcnt vmcnt(13)
    v_mfma_f32_32x32x16_bf16 v[28:43], v[84:87], v[60:63], 0
    v_exp_f32 v17, v17
    v_exp_f32 v18, v18
    v_exp_f32 v19, v19
    v_max3_u32 v11, v11, v80, v160
    v_permlane16_swap_b32 v160, v164
    v_permlane16_swap_b32 v161, v165
    v_permlane16_swap_b32 v162, v166
    v_permlane16_swap_b32 v163, v167
    s_xor_b32 s84, s85, 24576
    buffer_load_dwordx4 v[112:115], v10, s[56:59], s84 offen offset:0 sc1
    buffer_load_dwordx4 v[224:227], v10, s[56:59], s84 offen offset:1024 sc1
    buffer_load_dwordx4 v[116:119], v10, s[56:59], s84 offen offset:2048 sc1
    buffer_load_dwordx4 v[232:235], v10, s[56:59], s84 offen offset:3072 sc1
    v_exp_f32 v20, v20
    v_exp_f32 v21, v21
    v_exp_f32 v22, v22
    v_exp_f32 v23, v23
    v_exp_f32 v24, v24
    v_exp_f32 v25, v25
    v_exp_f32 v26, v26
    v_smfmac_f32_32x32x32_bf16 v[44:59], v[160:163], v[12:19], v1
    v_exp_f32 v27, v27
    v_exp_f32 v28, v28
    v_exp_f32 v29, v29
    v_smfmac_f32_32x32x32_bf16 v[44:59], v[164:167], v[20:27], v1
    v_exp_f32 v30, v30
    v_exp_f32 v31, v31
    v_exp_f32 v32, v32
    s_waitcnt vmcnt(15)
    v_mfma_f32_32x32x16_bf16 v[12:27], v[88:91], v[60:63], 0
    v_exp_f32 v33, v33
    v_exp_f32 v34, v34
    v_exp_f32 v35, v35
    v_max3_u32 v11, v11, v84, v168
    v_permlane16_swap_b32 v168, v172
    v_permlane16_swap_b32 v169, v173
    v_permlane16_swap_b32 v170, v174
    v_permlane16_swap_b32 v171, v175
    s_xor_b32 s84, s85, 28672
    buffer_load_dwordx4 v[120:123], v10, s[56:59], s84 offen offset:0 sc1
    buffer_load_dwordx4 v[240:243], v10, s[56:59], s84 offen offset:1024 sc1
    buffer_load_dwordx4 v[124:127], v10, s[56:59], s84 offen offset:2048 sc1
    buffer_load_dwordx4 v[248:251], v10, s[56:59], s84 offen offset:3072 sc1
    v_exp_f32 v36, v36
    v_exp_f32 v37, v37
    v_exp_f32 v38, v38
    v_exp_f32 v39, v39
    v_exp_f32 v40, v40
    v_exp_f32 v41, v41
    v_exp_f32 v42, v42
    v_smfmac_f32_32x32x32_bf16 v[44:59], v[168:171], v[28:35], v1
    v_exp_f32 v43, v43
    v_exp_f32 v12, v12
    v_exp_f32 v13, v13
    v_smfmac_f32_32x32x32_bf16 v[44:59], v[172:175], v[36:43], v1
    v_exp_f32 v14, v14
    v_exp_f32 v15, v15
    v_exp_f32 v16, v16
    s_waitcnt vmcnt(17)
    v_mfma_f32_32x32x16_bf16 v[28:43], v[92:95], v[60:63], 0
    v_exp_f32 v17, v17
    v_exp_f32 v18, v18
    v_exp_f32 v19, v19
    v_max3_u32 v11, v11, v88, v176
    v_permlane16_swap_b32 v176, v180
    v_permlane16_swap_b32 v177, v181
    v_permlane16_swap_b32 v178, v182
    v_permlane16_swap_b32 v179, v183
    s_mov_b64 exec, 1
    ds_add_u32 v9, v8 offset:64
    s_mov_b64 exec, -1
    v_exp_f32 v20, v20
    v_exp_f32 v21, v21
    v_exp_f32 v22, v22
    v_exp_f32 v23, v23
    v_exp_f32 v24, v24
    v_exp_f32 v25, v25
    v_exp_f32 v26, v26
    v_smfmac_f32_32x32x32_bf16 v[44:59], v[176:179], v[12:19], v1
    v_exp_f32 v27, v27
    v_exp_f32 v28, v28
    v_exp_f32 v29, v29
    v_smfmac_f32_32x32x32_bf16 v[44:59], v[180:183], v[20:27], v1
    v_exp_f32 v30, v30
    v_exp_f32 v31, v31
    v_exp_f32 v32, v32
    s_waitcnt vmcnt(15)
    v_mfma_f32_32x32x16_bf16 v[12:27], v[96:99], v[60:63], 0
    v_exp_f32 v33, v33
    v_exp_f32 v34, v34
    v_exp_f32 v35, v35
    v_max3_u32 v11, v11, v92, v184
    v_permlane16_swap_b32 v184, v188
    v_permlane16_swap_b32 v185, v189
    v_permlane16_swap_b32 v186, v190
    v_permlane16_swap_b32 v187, v191
    v_exp_f32 v36, v36
    v_exp_f32 v37, v37
    v_exp_f32 v38, v38
    v_exp_f32 v39, v39
    v_exp_f32 v40, v40
    v_exp_f32 v41, v41
    v_exp_f32 v42, v42
    v_smfmac_f32_32x32x32_bf16 v[44:59], v[184:187], v[28:35], v1
    v_exp_f32 v43, v43
    v_exp_f32 v12, v12
    v_exp_f32 v13, v13
    v_smfmac_f32_32x32x32_bf16 v[44:59], v[188:191], v[36:43], v1
    v_exp_f32 v14, v14
    v_exp_f32 v15, v15
    v_exp_f32 v16, v16
    s_waitcnt vmcnt(13)
    v_mfma_f32_32x32x16_bf16 v[28:43], v[100:103], v[60:63], 0
    v_exp_f32 v17, v17
    v_exp_f32 v18, v18
    v_exp_f32 v19, v19
    v_max3_u32 v11, v11, v96, v192
    v_permlane16_swap_b32 v192, v196
    v_permlane16_swap_b32 v193, v197
    v_permlane16_swap_b32 v194, v198
    v_permlane16_swap_b32 v195, v199
    v_exp_f32 v20, v20
    v_exp_f32 v21, v21
    v_exp_f32 v22, v22
    v_exp_f32 v23, v23
    v_exp_f32 v24, v24
    v_exp_f32 v25, v25
    v_exp_f32 v26, v26
    v_smfmac_f32_32x32x32_bf16 v[44:59], v[192:195], v[12:19], v1
    v_exp_f32 v27, v27
    v_exp_f32 v28, v28
    v_exp_f32 v29, v29
    v_smfmac_f32_32x32x32_bf16 v[44:59], v[196:199], v[20:27], v1
    v_exp_f32 v30, v30
    v_exp_f32 v31, v31
    v_exp_f32 v32, v32
    s_waitcnt vmcnt(11)
    v_mfma_f32_32x32x16_bf16 v[12:27], v[104:107], v[60:63], 0
    v_exp_f32 v33, v33
    v_exp_f32 v34, v34
    v_exp_f32 v35, v35
    v_max3_u32 v11, v11, v100, v200
    v_permlane16_swap_b32 v200, v204
    v_permlane16_swap_b32 v201, v205
    v_permlane16_swap_b32 v202, v206
    v_permlane16_swap_b32 v203, v207
    v_exp_f32 v36, v36
    v_exp_f32 v37, v37
    v_exp_f32 v38, v38
    v_exp_f32 v39, v39
    v_exp_f32 v40, v40
    v_exp_f32 v41, v41
    v_exp_f32 v42, v42
    v_smfmac_f32_32x32x32_bf16 v[44:59], v[200:203], v[28:35], v1
    v_exp_f32 v43, v43
    v_exp_f32 v12, v12
    v_exp_f32 v13, v13
    v_smfmac_f32_32x32x32_bf16 v[44:59], v[204:207], v[36:43], v1
    v_exp_f32 v14, v14
    v_exp_f32 v15, v15
    v_exp_f32 v16, v16
    s_waitcnt vmcnt(9)
    v_mfma_f32_32x32x16_bf16 v[28:43], v[108:111], v[60:63], 0
    v_exp_f32 v17, v17
    v_exp_f32 v18, v18
    v_exp_f32 v19, v19
    v_max3_u32 v11, v11, v104, v208
    v_permlane16_swap_b32 v208, v212
    v_permlane16_swap_b32 v209, v213
    v_permlane16_swap_b32 v210, v214
    v_permlane16_swap_b32 v211, v215
    v_exp_f32 v20, v20
    v_exp_f32 v21, v21
    v_exp_f32 v22, v22
    v_exp_f32 v23, v23
    v_exp_f32 v24, v24
    v_exp_f32 v25, v25
    v_exp_f32 v26, v26
    v_smfmac_f32_32x32x32_bf16 v[44:59], v[208:211], v[12:19], v1
    v_exp_f32 v27, v27
    v_exp_f32 v28, v28
    v_exp_f32 v29, v29
    v_smfmac_f32_32x32x32_bf16 v[44:59], v[212:215], v[20:27], v1
    v_exp_f32 v30, v30
    v_exp_f32 v31, v31
    v_exp_f32 v32, v32
    s_waitcnt vmcnt(7)
    v_mfma_f32_32x32x16_bf16 v[12:27], v[112:115], v[60:63], 0
    v_exp_f32 v33, v33
    v_exp_f32 v34, v34
    v_exp_f32 v35, v35
    v_max3_u32 v11, v11, v108, v216
    v_permlane16_swap_b32 v216, v220
    v_permlane16_swap_b32 v217, v221
    v_permlane16_swap_b32 v218, v222
    v_permlane16_swap_b32 v219, v223
    v_exp_f32 v36, v36
    v_exp_f32 v37, v37
    v_exp_f32 v38, v38
    v_exp_f32 v39, v39
    v_exp_f32 v40, v40
    v_exp_f32 v41, v41
    v_exp_f32 v42, v42
    v_smfmac_f32_32x32x32_bf16 v[44:59], v[216:219], v[28:35], v1
    v_exp_f32 v43, v43
    v_exp_f32 v12, v12
    v_exp_f32 v13, v13
    v_smfmac_f32_32x32x32_bf16 v[44:59], v[220:223], v[36:43], v1
    v_exp_f32 v14, v14
    v_exp_f32 v15, v15
    v_exp_f32 v16, v16
    s_waitcnt vmcnt(5)
    v_mfma_f32_32x32x16_bf16 v[28:43], v[116:119], v[60:63], 0
    v_exp_f32 v17, v17
    v_exp_f32 v18, v18
    v_exp_f32 v19, v19
    v_max3_u32 v11, v11, v112, v224
    v_permlane16_swap_b32 v224, v228
    v_permlane16_swap_b32 v225, v229
    v_permlane16_swap_b32 v226, v230
    v_permlane16_swap_b32 v227, v231
    v_exp_f32 v20, v20
    v_exp_f32 v21, v21
    v_exp_f32 v22, v22
    v_exp_f32 v23, v23
    v_exp_f32 v24, v24
    v_exp_f32 v25, v25
    v_exp_f32 v26, v26
    v_smfmac_f32_32x32x32_bf16 v[44:59], v[224:227], v[12:19], v1
    v_exp_f32 v27, v27
    v_exp_f32 v28, v28
    v_exp_f32 v29, v29
    v_smfmac_f32_32x32x32_bf16 v[44:59], v[228:231], v[20:27], v1
    v_exp_f32 v30, v30
    v_exp_f32 v31, v31
    v_exp_f32 v32, v32
    s_waitcnt vmcnt(3)
    v_mfma_f32_32x32x16_bf16 v[12:27], v[120:123], v[60:63], 0
    v_exp_f32 v33, v33
    v_exp_f32 v34, v34
    v_exp_f32 v35, v35
    v_max3_u32 v11, v11, v116, v232
    v_permlane16_swap_b32 v232, v236
    v_permlane16_swap_b32 v233, v237
    v_permlane16_swap_b32 v234, v238
    v_permlane16_swap_b32 v235, v239
    v_exp_f32 v36, v36
    v_exp_f32 v37, v37
    v_exp_f32 v38, v38
    v_exp_f32 v39, v39
    v_exp_f32 v40, v40
    v_exp_f32 v41, v41
    v_exp_f32 v42, v42
    v_smfmac_f32_32x32x32_bf16 v[44:59], v[232:235], v[28:35], v1
    v_exp_f32 v43, v43
    v_exp_f32 v12, v12
    v_exp_f32 v13, v13
    v_smfmac_f32_32x32x32_bf16 v[44:59], v[236:239], v[36:43], v1
    v_exp_f32 v14, v14
    v_exp_f32 v15, v15
    v_exp_f32 v16, v16
    s_waitcnt vmcnt(1)
    v_mfma_f32_32x32x16_bf16 v[28:43], v[124:127], v[60:63], 0
    ds_read_b128 v[60:63], v4 offset:1024
    v_exp_f32 v17, v17
    v_exp_f32 v18, v18
    v_exp_f32 v19, v19
    v_max3_u32 v11, v11, v120, v240
    v_permlane16_swap_b32 v240, v244
    v_permlane16_swap_b32 v241, v245
    v_permlane16_swap_b32 v242, v246
    v_permlane16_swap_b32 v243, v247
    v_exp_f32 v20, v20
    v_exp_f32 v21, v21
    v_exp_f32 v22, v22
    v_exp_f32 v23, v23
    v_exp_f32 v24, v24
    v_exp_f32 v25, v25
    v_exp_f32 v26, v26
    v_smfmac_f32_32x32x32_bf16 v[44:59], v[240:243], v[12:19], v1
    v_exp_f32 v27, v27
    v_exp_f32 v28, v28
    v_exp_f32 v29, v29
    v_smfmac_f32_32x32x32_bf16 v[44:59], v[244:247], v[20:27], v1
    v_exp_f32 v30, v30
    v_exp_f32 v31, v31
    v_exp_f32 v32, v32
    s_waitcnt vmcnt(0) lgkmcnt(0)
    v_mfma_f32_32x32x16_bf16 v[12:27], v[64:67], v[60:63], 0
    v_exp_f32 v33, v33
    v_exp_f32 v34, v34
    v_exp_f32 v35, v35
    v_max3_u32 v11, v11, v124, v248
    v_permlane16_swap_b32 v248, v252
    v_permlane16_swap_b32 v249, v253
    v_permlane16_swap_b32 v250, v254
    v_permlane16_swap_b32 v251, v255
    v_exp_f32 v36, v36
    v_exp_f32 v37, v37
    v_cmp_eq_u32 vcc, -1, v11
    v_exp_f32 v38, v38
    v_exp_f32 v39, v39
    v_exp_f32 v40, v40
    v_exp_f32 v41, v41
    s_cbranch_vccnz L_aw_redo
L_aw_go:
    v_exp_f32 v42, v42
    v_smfmac_f32_32x32x32_bf16 v[44:59], v[248:251], v[28:35], v1
    v_exp_f32 v43, v43
    v_exp_f32 v12, v12
    v_exp_f32 v13, v13
    v_smfmac_f32_32x32x32_bf16 v[44:59], v[252:255], v[36:43], v1
    v_exp_f32 v14, v14
    v_exp_f32 v15, v15
    v_exp_f32 v16, v16
    v_mfma_f32_32x32x16_bf16 v[28:43], v[68:71], v[60:63], 0
    v_exp_f32 v17, v17
    v_exp_f32 v18, v18
    v_exp_f32 v19, v19
    v_exp_f32 v20, v20
    v_exp_f32 v21, v21
    v_exp_f32 v22, v22
    ds_write_b128 v5, v[44:47] offset:0
    v_exp_f32 v23, v23
    v_exp_f32 v24, v24
    ds_write_b128 v5, v[48:51] offset:1024
    v_exp_f32 v25, v25
    v_exp_f32 v26, v26
    ds_write_b32 v6, v52 offset:0
    v_mfma_f32_32x32x8_bf16 v[44:59], v[2:3], v[2:3], 0
    v_exp_f32 v27, v27
    v_exp_f32 v28, v28
    v_exp_f32 v29, v29
    v_smfmac_f32_32x32x32_bf16 v[44:59], v[128:131], v[12:19], v1
    v_exp_f32 v30, v30
    v_exp_f32 v31, v31
    v_exp_f32 v32, v32
    v_smfmac_f32_32x32x32_bf16 v[44:59], v[132:135], v[20:27], v1
    v_exp_f32 v33, v33
    v_exp_f32 v34, v34
    v_exp_f32 v35, v35
    v_mfma_f32_32x32x16_bf16 v[12:27], v[72:75], v[60:63], 0
    v_exp_f32 v36, v36
    v_exp_f32 v37, v37
    v_exp_f32 v38, v38
    v_exp_f32 v39, v39
    v_exp_f32 v40, v40
    v_exp_f32 v41, v41
    v_exp_f32 v42, v42
    v_smfmac_f32_32x32x32_bf16 v[44:59], v[136:139], v[28:35], v1
    v_exp_f32 v43, v43
    v_exp_f32 v12, v12
    v_exp_f32 v13, v13
    v_smfmac_f32_32x32x32_bf16 v[44:59], v[140:143], v[36:43], v1
    v_exp_f32 v14, v14
    v_exp_f32 v15, v15
    v_exp_f32 v16, v16
    v_mfma_f32_32x32x16_bf16 v[28:43], v[76:79], v[60:63], 0
    v_exp_f32 v17, v17
    v_exp_f32 v18, v18
    v_exp_f32 v19, v19
    v_exp_f32 v20, v20
    v_exp_f32 v21, v21
    v_exp_f32 v22, v22
    v_exp_f32 v23, v23
    v_exp_f32 v24, v24
    v_exp_f32 v25, v25
    v_exp_f32 v26, v26
    v_smfmac_f32_32x32x32_bf16 v[44:59], v[144:147], v[12:19], v1
    v_exp_f32 v27, v27
    v_exp_f32 v28, v28
    v_exp_f32 v29, v29
    v_smfmac_f32_32x32x32_bf16 v[44:59], v[148:151], v[20:27], v1
    v_exp_f32 v30, v30
    v_exp_f32 v31, v31
    v_exp_f32 v32, v32
    v_mfma_f32_32x32x16_bf16 v[12:27], v[80:83], v[60:63], 0
    v_exp_f32 v33, v33
    v_exp_f32 v34, v34
    v_exp_f32 v35, v35
    v_exp_f32 v36, v36
    v_exp_f32 v37, v37
    v_exp_f32 v38, v38
    v_exp_f32 v39, v39
    v_exp_f32 v40, v40
    v_exp_f32 v41, v41
    v_exp_f32 v42, v42
    v_smfmac_f32_32x32x32_bf16 v[44:59], v[152:155], v[28:35], v1
    v_exp_f32 v43, v43
    v_exp_f32 v12, v12
    v_exp_f32 v13, v13
    v_smfmac_f32_32x32x32_bf16 v[44:59], v[156:159], v[36:43], v1
    v_exp_f32 v14, v14
    v_exp_f32 v15, v15
    v_exp_f32 v16, v16
    v_mfma_f32_32x32x16_bf16 v[28:43], v[84:87], v[60:63], 0
    v_exp_f32 v17, v17
    v_exp_f32 v18, v18
    v_exp_f32 v19, v19
    v_exp_f32 v20, v20
    v_exp_f32 v21, v21
    v_exp_f32 v22, v22
    v_exp_f32 v23, v23
    v_exp_f32 v24, v24
    v_exp_f32 v25, v25
    v_exp_f32 v26, v26
    v_smfmac_f32_32x32x32_bf16 v[44:59], v[160:163], v[12:19], v1
    v_exp_f32 v27, v27
    v_exp_f32 v28, v28
    v_exp_f32 v29, v29
    v_smfmac_f32_32x32x32_bf16 v[44:59], v[164:167], v[20:27], v1
    v_exp_f32 v30, v30
    v_exp_f32 v31, v31
    v_exp_f32 v32, v32
    v_mfma_f32_32x32x16_bf16 v[12:27], v[88:91], v[60:63], 0
    v_exp_f32 v33, v33
    v_exp_f32 v34, v34
    v_exp_f32 v35, v35
    v_exp_f32 v36, v36
    v_exp_f32 v37, v37
    v_exp_f32 v38, v38
    v_exp_f32 v39, v39
    v_exp_f32 v40, v40
    v_exp_f32 v41, v41
    v_exp_f32 v42, v42
    v_smfmac_f32_32x32x32_bf16 v[44:59], v[168:171], v[28:35], v1
    v_exp_f32 v43, v43
    v_exp_f32 v12, v12
    v_exp_f32 v13, v13
    v_smfmac_f32_32x32x32_bf16 v[44:59], v[172:175], v[36:43], v1
    v_exp_f32 v14, v14
    v_exp_f32 v15, v15
    v_exp_f32 v16, v16
    v_mfma_f32_32x32x16_bf16 v[28:43], v[92:95], v[60:63], 0
    v_exp_f32 v17, v17
    v_exp_f32 v18, v18
    v_exp_f32 v19, v19
    v_exp_f32 v20, v20
    v_exp_f32 v21, v21
    v_exp_f32 v22, v22
    v_exp_f32 v23, v23
    v_exp_f32 v24, v24
    v_exp_f32 v25, v25
    v_exp_f32 v26, v26
    v_smfmac_f32_32x32x32_bf16 v[44:59], v[176:179], v[12:19], v1
    v_exp_f32 v27, v27
    v_exp_f32 v28, v28
    v_exp_f32 v29, v29
    v_smfmac_f32_32x32x32_bf16 v[44:59], v[180:183], v[20:27], v1
    v_exp_f32 v30, v30
    v_exp_f32 v31, v31
    v_exp_f32 v32, v32
    v_mfma_f32_32x32x16_bf16 v[12:27], v[96:99], v[60:63], 0
    v_exp_f32 v33, v33
    v_exp_f32 v34, v34
    v_exp_f32 v35, v35
    v_exp_f32 v36, v36
    v_exp_f32 v37, v37
    v_exp_f32 v38, v38
    v_exp_f32 v39, v39
    v_exp_f32 v40, v40
    v_exp_f32 v41, v41
    v_exp_f32 v42, v42
    v_smfmac_f32_32x32x32_bf16 v[44:59], v[184:187], v[28:35], v1
    v_exp_f32 v43, v43
    v_exp_f32 v12, v12
    v_exp_f32 v13, v13
    v_smfmac_f32_32x32x32_bf16 v[44:59], v[188:191], v[36:43], v1
    v_exp_f32 v14, v14
    v_exp_f32 v15, v15
    v_exp_f32 v16, v16
    v_mfma_f32_32x32x16_bf16 v[28:43], v[100:103], v[60:63], 0
    v_exp_f32 v17, v17
    v_exp_f32 v18, v18
    v_exp_f32 v19, v19
    v_exp_f32 v20, v20
    v_exp_f32 v21, v21
    v_exp_f32 v22, v22
    v_exp_f32 v23, v23
    v_exp_f32 v24, v24
    v_exp_f32 v25, v25
    v_exp_f32 v26, v26
    v_smfmac_f32_32x32x32_bf16 v[44:59], v[192:195], v[12:19], v1
    v_exp_f32 v27, v27
    v_exp_f32 v28, v28
    v_exp_f32 v29, v29
    v_smfmac_f32_32x32x32_bf16 v[44:59], v[196:199], v[20:27], v1
    v_exp_f32 v30, v30
    v_exp_f32 v31, v31
    v_exp_f32 v32, v32
    v_mfma_f32_32x32x16_bf16 v[12:27], v[104:107], v[60:63], 0
    v_exp_f32 v33, v33
    v_exp_f32 v34, v34
    v_exp_f32 v35, v35
    v_exp_f32 v36, v36
    v_exp_f32 v37, v37
    v_exp_f32 v38, v38
    v_exp_f32 v39, v39
    v_exp_f32 v40, v40
    v_exp_f32 v41, v41
    v_exp_f32 v42, v42
    v_smfmac_f32_32x32x32_bf16 v[44:59], v[200:203], v[28:35], v1
    v_exp_f32 v43, v43
    v_exp_f32 v12, v12
    v_exp_f32 v13, v13
    v_smfmac_f32_32x32x32_bf16 v[44:59], v[204:207], v[36:43], v1
    v_exp_f32 v14, v14
    v_exp_f32 v15, v15
    v_exp_f32 v16, v16
    v_mfma_f32_32x32x16_bf16 v[28:43], v[108:111], v[60:63], 0
    v_exp_f32 v17, v17
    v_exp_f32 v18, v18
    v_exp_f32 v19, v19
    v_exp_f32 v20, v20
    v_exp_f32 v21, v21
    v_exp_f32 v22, v22
    v_exp_f32 v23, v23
    v_exp_f32 v24, v24
    v_exp_f32 v25, v25
    v_exp_f32 v26, v26
    v_smfmac_f32_32x32x32_bf16 v[44:59], v[208:211], v[12:19], v1
    v_exp_f32 v27, v27
    v_exp_f32 v28, v28
    v_exp_f32 v29, v29
    v_smfmac_f32_32x32x32_bf16 v[44:59], v[212:215], v[20:27], v1
    v_exp_f32 v30, v30
    v_exp_f32 v31, v31
    v_exp_f32 v32, v32
    v_mfma_f32_32x32x16_bf16 v[12:27], v[112:115], v[60:63], 0
    v_exp_f32 v33, v33
    v_exp_f32 v34, v34
    v_exp_f32 v35, v35
    v_exp_f32 v36, v36
    v_exp_f32 v37, v37
    v_exp_f32 v38, v38
    v_exp_f32 v39, v39
    v_exp_f32 v40, v40
    v_exp_f32 v41, v41
    v_exp_f32 v42, v42
    v_smfmac_f32_32x32x32_bf16 v[44:59], v[216:219], v[28:35], v1
    v_exp_f32 v43, v43
    v_exp_f32 v12, v12
    v_exp_f32 v13, v13
    v_smfmac_f32_32x32x32_bf16 v[44:59], v[220:223], v[36:43], v1
    v_exp_f32 v14, v14
    v_exp_f32 v15, v15
    v_exp_f32 v16, v16
    v_mfma_f32_32x32x16_bf16 v[28:43], v[116:119], v[60:63], 0
    v_exp_f32 v17, v17
    v_exp_f32 v18, v18
    v_exp_f32 v19, v19
    v_exp_f32 v20, v20
    v_exp_f32 v21, v21
    v_exp_f32 v22, v22
    v_exp_f32 v23, v23
    v_exp_f32 v24, v24
    v_exp_f32 v25, v25
    v_exp_f32 v26, v26
    v_smfmac_f32_32x32x32_bf16 v[44:59], v[224:227], v[12:19], v1
    v_exp_f32 v27, v27
    v_exp_f32 v28, v28
    v_exp_f32 v29, v29
    v_smfmac_f32_32x32x32_bf16 v[44:59], v[228:231], v[20:27], v1
    v_exp_f32 v30, v30
    v_exp_f32 v31, v31
    v_exp_f32 v32, v32
    v_mfma_f32_32x32x16_bf16 v[12:27], v[120:123], v[60:63], 0
    v_exp_f32 v33, v33
    v_exp_f32 v34, v34
    v_exp_f32 v35, v35
    v_exp_f32 v36, v36
    v_exp_f32 v37, v37
    v_exp_f32 v38, v38
    v_exp_f32 v39, v39
    v_exp_f32 v40, v40
    v_exp_f32 v41, v41
    v_exp_f32 v42, v42
    v_smfmac_f32_32x32x32_bf16 v[44:59], v[232:235], v[28:35], v1
    v_exp_f32 v43, v43
    v_exp_f32 v12, v12
    v_exp_f32 v13, v13
    v_smfmac_f32_32x32x32_bf16 v[44:59], v[236:239], v[36:43], v1
    v_exp_f32 v14, v14
    v_exp_f32 v15, v15
    v_exp_f32 v16, v16
    v_mfma_f32_32x32x16_bf16 v[28:43], v[124:127], v[60:63], 0
    ds_read_b128 v[60:63], v4 offset:2048
    v_exp_f32 v17, v17
    v_exp_f32 v18, v18
    v_exp_f32 v19, v19
    v_exp_f32 v20, v20
    v_exp_f32 v21, v21
    v_exp_f32 v22, v22
    v_exp_f32 v23, v23
    v_exp_f32 v24, v24
    v_exp_f32 v25, v25
    v_exp_f32 v26, v26
    v_smfmac_f32_32x32x32_bf16 v[44:59], v[240:243], v[12:19], v1
    v_exp_f32 v27, v27
    v_exp_f32 v28, v28
    v_exp_f32 v29, v29
    v_smfmac_f32_32x32x32_bf16 v[44:59], v[244:247], v[20:27], v1
    v_exp_f32 v30, v30
    v_exp_f32 v31, v31
    v_exp_f32 v32, v32
    s_waitcnt lgkmcnt(0)
    v_mfma_f32_32x32x16_bf16 v[12:27], v[64:67], v[60:63], 0
    v_exp_f32 v33, v33
    v_exp_f32 v34, v34
    v_exp_f32 v35, v35
    v_exp_f32 v36, v36
    v_exp_f32 v37, v37
    v_exp_f32 v38, v38
    v_exp_f32 v39, v39
    v_exp_f32 v40, v40
    v_exp_f32 v41, v41
    v_exp_f32 v42, v42
    v_smfmac_f32_32x32x32_bf16 v[44:59], v[248:251], v[28:35], v1
    v_exp_f32 v43, v43
    s_branch L_aw_pg2
.p2align 12
L_aw_visit2:
    s_branch L_aw_visit4
    s_nop 0
L_aw_pg2:
    v_exp_f32 v12, v12
    v_exp_f32 v13, v13
    v_smfmac_f32_32x32x32_bf16 v[44:59], v[252:255], v[36:43], v1
    v_exp_f32 v14, v14
    v_exp_f32 v15, v15
    v_exp_f32 v16, v16
    v_mfma_f32_32x32x16_bf16 v[28:43], v[68:71], v[60:63], 0
    v_exp_f32 v17, v17
    v_exp_f32 v18, v18
    v_exp_f32 v19, v19
    v_exp_f32 v20, v20
    v_exp_f32 v21, v21
    v_exp_f32 v22, v22
    ds_write_b128 v5, v[44:47] offset:8192
    v_exp_f32 v23, v23
    v_exp_f32 v24, v24
    ds_write_b128 v5, v[48:51] offset:9216
    v_exp_f32 v25, v25
    v_exp_f32 v26, v26
    ds_write_b32 v6, v52 offset:1024
    v_mfma_f32_32x32x8_bf16 v[44:59], v[2:3], v[2:3], 0
    v_exp_f32 v27, v27
    v_exp_f32 v28, v28
    v_exp_f32 v29, v29
    v_smfmac_f32_32x32x32_bf16 v[44:59], v[128:131], v[12:19], v1
    v_exp_f32 v30, v30
    v_exp_f32 v31, v31
    v_exp_f32 v32, v32
    v_smfmac_f32_32x32x32_bf16 v[44:59], v[132:135], v[20:27], v1
    v_exp_f32 v33, v33
    v_exp_f32 v34, v34
    v_exp_f32 v35, v35
    v_mfma_f32_32x32x16_bf16 v[12:27], v[72:75], v[60:63], 0
    v_exp_f32 v36, v36
    v_exp_f32 v37, v37
    v_exp_f32 v38, v38
    v_exp_f32 v39, v39
    v_exp_f32 v40, v40
    v_exp_f32 v41, v41
    v_exp_f32 v42, v42
    v_smfmac_f32_32x32x32_bf16 v[44:59], v[136:139], v[28:35], v1
    v_exp_f32 v43, v43
    v_exp_f32 v12, v12
    v_exp_f32 v13, v13
    v_smfmac_f32_32x32x32_bf16 v[44:59], v[140:143], v[36:43], v1
    v_exp_f32 v14, v14
    v_exp_f32 v15, v15
    v_exp_f32 v16, v16
    v_mfma_f32_32x32x16_bf16 v[28:43], v[76:79], v[60:63], 0
    v_exp_f32 v17, v17
    v_exp_f32 v18, v18
    v_exp_f32 v19, v19
    v_exp_f32 v20, v20
    v_exp_f32 v21, v21
    v_exp_f32 v22, v22
    v_exp_f32 v23, v23
    v_exp_f32 v24, v24
    v_exp_f32 v25, v25
    v_exp_f32 v26, v26
    v_smfmac_f32_32x32x32_bf16 v[44:59], v[144:147], v[12:19], v1
    v_exp_f32 v27, v27
    v_exp_f32 v28, v28
    v_exp_f32 v29, v29
    v_smfmac_f32_32x32x32_bf16 v[44:59], v[148:151], v[20:27], v1
    v_exp_f32 v30, v30
    v_exp_f32 v31, v31
    v_exp_f32 v32, v32
    v_mfma_f32_32x32x16_bf16 v[12:27], v[80:83], v[60:63], 0
    v_exp_f32 v33, v33
    v_exp_f32 v34, v34
    v_exp_f32 v35, v35
    v_exp_f32 v36, v36
    v_exp_f32 v37, v37
    v_exp_f32 v38, v38
    v_exp_f32 v39, v39
    v_exp_f32 v40, v40
    v_exp_f32 v41, v41
    v_exp_f32 v42, v42
    v_smfmac_f32_32x32x32_bf16 v[44:59], v[152:155], v[28:35], v1
    v_exp_f32 v43, v43
    v_exp_f32 v12, v12
    v_exp_f32 v13, v13
    v_smfmac_f32_32x32x32_bf16 v[44:59], v[156:159], v[36:43], v1
    v_exp_f32 v14, v14
    v_exp_f32 v15, v15
    v_exp_f32 v16, v16
    v_mfma_f32_32x32x16_bf16 v[28:43], v[84:87], v[60:63], 0
    v_exp_f32 v17, v17
    v_exp_f32 v18, v18
    v_exp_f32 v19, v19
    v_exp_f32 v20, v20
    v_exp_f32 v21, v21
    v_exp_f32 v22, v22
    v_exp_f32 v23, v23
    v_exp_f32 v24, v24
    v_exp_f32 v25, v25
    v_exp_f32 v26, v26
    v_smfmac_f32_32x32x32_bf16 v[44:59], v[160:163], v[12:19], v1
    v_exp_f32 v27, v27
    v_exp_f32 v28, v28
    v_exp_f32 v29, v29
    v_smfmac_f32_32x32x32_bf16 v[44:59], v[164:167], v[20:27], v1
    v_exp_f32 v30, v30
    v_exp_f32 v31, v31
    v_exp_f32 v32, v32
    v_mfma_f32_32x32x16_bf16 v[12:27], v[88:91], v[60:63], 0
    v_exp_f32 v33, v33
    v_exp_f32 v34, v34
    v_exp_f32 v35, v35
    v_exp_f32 v36, v36
    v_exp_f32 v37, v37
    v_exp_f32 v38, v38
    v_exp_f32 v39, v39
    v_exp_f32 v40, v40
    v_exp_f32 v41, v41
    v_exp_f32 v42, v42
    v_smfmac_f32_32x32x32_bf16 v[44:59], v[168:171], v[28:35], v1
    v_exp_f32 v43, v43
    v_exp_f32 v12, v12
    v_exp_f32 v13, v13
    v_smfmac_f32_32x32x32_bf16 v[44:59], v[172:175], v[36:43], v1
    v_exp_f32 v14, v14
    v_exp_f32 v15, v15
    v_exp_f32 v16, v16
    v_mfma_f32_32x32x16_bf16 v[28:43], v[92:95], v[60:63], 0
    v_exp_f32 v17, v17
    v_exp_f32 v18, v18
    v_exp_f32 v19, v19
    v_exp_f32 v20, v20
    v_exp_f32 v21, v21
    v_exp_f32 v22, v22
    v_exp_f32 v23, v23
    v_exp_f32 v24, v24
    v_exp_f32 v25, v25
    v_exp_f32 v26, v26
    v_smfmac_f32_32x32x32_bf16 v[44:59], v[176:179], v[12:19], v1
    v_exp_f32 v27, v27
    v_exp_f32 v28, v28
    v_exp_f32 v29, v29
    v_smfmac_f32_32x32x32_bf16 v[44:59], v[180:183], v[20:27], v1
    v_exp_f32 v30, v30
    v_exp_f32 v31, v31
    v_exp_f32 v32, v32
    v_mfma_f32_32x32x16_bf16 v[12:27], v[96:99], v[60:63], 0
    v_exp_f32 v33, v33
    v_exp_f32 v34, v34
    v_exp_f32 v35, v35
    v_exp_f32 v36, v36
    v_exp_f32 v37, v37
    v_exp_f32 v38, v38
    v_exp_f32 v39, v39
    v_exp_f32 v40, v40
    v_exp_f32 v41, v41
    v_exp_f32 v42, v42
    v_smfmac_f32_32x32x32_bf16 v[44:59], v[184:187], v[28:35], v1
    v_exp_f32 v43, v43
    v_exp_f32 v12, v12
    v_exp_f32 v13, v13
    v_smfmac_f32_32x32x32_bf16 v[44:59], v[188:191], v[36:43], v1
    v_exp_f32 v14, v14
    v_exp_f32 v15, v15
    v_exp_f32 v16, v16
    v_mfma_f32_32x32x16_bf16 v[28:43], v[100:103], v[60:63], 0
    v_exp_f32 v17, v17
    v_exp_f32 v18, v18
    v_exp_f32 v19, v19
    v_exp_f32 v20, v20
    v_exp_f32 v21, v21
    v_exp_f32 v22, v22
    v_exp_f32 v23, v23
    v_exp_f32 v24, v24
    v_exp_f32 v25, v25
    v_exp_f32 v26, v26
    v_smfmac_f32_32x32x32_bf16 v[44:59], v[192:195], v[12:19], v1
    v_exp_f32 v27, v27
    v_exp_f32 v28, v28
    v_exp_f32 v29, v29
    v_smfmac_f32_32x32x32_bf16 v[44:59], v[196:199], v[20:27], v1
    v_exp_f32 v30, v30
    v_exp_f32 v31, v31
    v_exp_f32 v32, v32
    v_mfma_f32_32x32x16_bf16 v[12:27], v[104:107], v[60:63], 0
    v_exp_f32 v33, v33
    v_exp_f32 v34, v34
    v_exp_f32 v35, v35
    v_exp_f32 v36, v36
    v_exp_f32 v37, v37
    v_exp_f32 v38, v38
    v_exp_f32 v39, v39
    v_exp_f32 v40, v40
    v_exp_f32 v41, v41
    v_exp_f32 v42, v42
    v_smfmac_f32_32x32x32_bf16 v[44:59], v[200:203], v[28:35], v1
    v_exp_f32 v43, v43
    v_exp_f32 v12, v12
    v_exp_f32 v13, v13
    v_smfmac_f32_32x32x32_bf16 v[44:59], v[204:207], v[36:43], v1
    v_exp_f32 v14, v14
    v_exp_f32 v15, v15
    v_exp_f32 v16, v16
    v_mfma_f32_32x32x16_bf16 v[28:43], v[108:111], v[60:63], 0
    v_exp_f32 v17, v17
    v_exp_f32 v18, v18
    v_exp_f32 v19, v19
    v_exp_f32 v20, v20
    v_exp_f32 v21, v21
    v_exp_f32 v22, v22
    v_exp_f32 v23, v23
    v_exp_f32 v24, v24
    v_exp_f32 v25, v25
    v_exp_f32 v26, v26
    v_smfmac_f32_32x32x32_bf16 v[44:59], v[208:211], v[12:19], v1
    v_exp_f32 v27, v27
    v_exp_f32 v28, v28
    v_exp_f32 v29, v29
    v_smfmac_f32_32x32x32_bf16 v[44:59], v[212:215], v[20:27], v1
    v_exp_f32 v30, v30
    v_exp_f32 v31, v31
    v_exp_f32 v32, v32
    v_mfma_f32_32x32x16_bf16 v[12:27], v[112:115], v[60:63], 0
    v_exp_f32 v33, v33
    v_exp_f32 v34, v34
    v_exp_f32 v35, v35
    v_exp_f32 v36, v36
    v_exp_f32 v37, v37
    v_exp_f32 v38, v38
    v_exp_f32 v39, v39
    v_exp_f32 v40, v40
    v_exp_f32 v41, v41
    v_exp_f32 v42, v42
    v_smfmac_f32_32x32x32_bf16 v[44:59], v[216:219], v[28:35], v1
    v_exp_f32 v43, v43
    v_exp_f32 v12, v12
    v_exp_f32 v13, v13
    v_smfmac_f32_32x32x32_bf16 v[44:59], v[220:223], v[36:43], v1
    v_exp_f32 v14, v14
    v_exp_f32 v15, v15
    v_exp_f32 v16, v16
    v_mfma_f32_32x32x16_bf16 v[28:43], v[116:119], v[60:63], 0
    v_exp_f32 v17, v17
    v_exp_f32 v18, v18
    v_exp_f32 v19, v19
    v_exp_f32 v20, v20
    v_exp_f32 v21, v21
    v_exp_f32 v22, v22
    v_exp_f32 v23, v23
    v_exp_f32 v24, v24
    v_exp_f32 v25, v25
    v_exp_f32 v26, v26
    v_smfmac_f32_32x32x32_bf16 v[44:59], v[224:227], v[12:19], v1
    v_exp_f32 v27, v27
    v_exp_f32 v28, v28
    v_exp_f32 v29, v29
    v_smfmac_f32_32x32x32_bf16 v[44:59], v[228:231], v[20:27], v1
    v_exp_f32 v30, v30
    v_exp_f32 v31, v31
    v_exp_f32 v32, v32
    v_mfma_f32_32x32x16_bf16 v[12:27], v[120:123], v[60:63], 0
    v_exp_f32 v33, v33
    v_exp_f32 v34, v34
    v_exp_f32 v35, v35
    v_exp_f32 v36, v36
    v_exp_f32 v37, v37
    v_exp_f32 v38, v38
    v_exp_f32 v39, v39
    v_exp_f32 v40, v40
    v_exp_f32 v41, v41
    v_exp_f32 v42, v42
    v_smfmac_f32_32x32x32_bf16 v[44:59], v[232:235], v[28:35], v1
    v_exp_f32 v43, v43
    v_exp_f32 v12, v12
    v_exp_f32 v13, v13
    v_smfmac_f32_32x32x32_bf16 v[44:59], v[236:239], v[36:43], v1
    v_exp_f32 v14, v14
    v_exp_f32 v15, v15
    v_exp_f32 v16, v16
    v_mfma_f32_32x32x16_bf16 v[28:43], v[124:127], v[60:63], 0
    ds_read_b128 v[60:63], v4 offset:3072
    v_exp_f32 v17, v17
    v_exp_f32 v18, v18
    v_exp_f32 v19, v19
    v_exp_f32 v20, v20
    v_exp_f32 v21, v21
    v_exp_f32 v22, v22
    v_exp_f32 v23, v23
    v_exp_f32 v24, v24
    v_exp_f32 v25, v25
    v_exp_f32 v26, v26
    v_smfmac_f32_32x32x32_bf16 v[44:59], v[240:243], v[12:19], v1
    v_exp_f32 v27, v27
    v_exp_f32 v28, v28
    v_exp_f32 v29, v29
    v_smfmac_f32_32x32x32_bf16 v[44:59], v[244:247], v[20:27], v1
    v_exp_f32 v30, v30
    v_exp_f32 v31, v31
    v_exp_f32 v32, v32
    s_waitcnt lgkmcnt(0)
    v_mfma_f32_32x32x16_bf16 v[12:27], v[64:67], v[60:63], 0
    v_exp_f32 v33, v33
    v_exp_f32 v34, v34
    v_exp_f32 v35, v35
    v_exp_f32 v36, v36
    v_exp_f32 v37, v37
    v_exp_f32 v38, v38
    v_exp_f32 v39, v39
    v_exp_f32 v40, v40
    v_exp_f32 v41, v41
    v_exp_f32 v42, v42
    v_smfmac_f32_32x32x32_bf16 v[44:59], v[248:251], v[28:35], v1
    v_exp_f32 v43, v43
    v_exp_f32 v12, v12
    v_exp_f32 v13, v13
    v_smfmac_f32_32x32x32_bf16 v[44:59], v[252:255], v[36:43], v1
    v_exp_f32 v14, v14
    v_exp_f32 v15, v15
    v_exp_f32 v16, v16
    v_mfma_f32_32x32x16_bf16 v[28:43], v[68:71], v[60:63], 0
    v_exp_f32 v17, v17
    v_exp_f32 v18, v18
    v_exp_f32 v19, v19
    v_exp_f32 v20, v20
    v_exp_f32 v21, v21
    v_exp_f32 v22, v22
    ds_write_b128 v5, v[44:47] offset:16384
    v_exp_f32 v23, v23
    v_exp_f32 v24, v24
    ds_write_b128 v5, v[48:51] offset:17408
    v_exp_f32 v25, v25
    v_exp_f32 v26, v26
    ds_write_b32 v6, v52 offset:2048
    v_mfma_f32_32x32x8_bf16 v[44:59], v[2:3], v[2:3], 0
    v_exp_f32 v27, v27
    v_exp_f32 v28, v28
    v_exp_f32 v29, v29
    v_smfmac_f32_32x32x32_bf16 v[44:59], v[128:131], v[12:19], v1
    v_exp_f32 v30, v30
    v_exp_f32 v31, v31
    v_exp_f32 v32, v32
    v_smfmac_f32_32x32x32_bf16 v[44:59], v[132:135], v[20:27], v1
    v_exp_f32 v33, v33
    v_exp_f32 v34, v34
    v_exp_f32 v35, v35
    v_mfma_f32_32x32x16_bf16 v[12:27], v[72:75], v[60:63], 0
    v_exp_f32 v36, v36
    v_exp_f32 v37, v37
    v_exp_f32 v38, v38
    v_exp_f32 v39, v39
    v_exp_f32 v40, v40
    v_exp_f32 v41, v41
    v_exp_f32 v42, v42
    v_smfmac_f32_32x32x32_bf16 v[44:59], v[136:139], v[28:35], v1
    v_exp_f32 v43, v43
    v_exp_f32 v12, v12
    v_exp_f32 v13, v13
    v_smfmac_f32_32x32x32_bf16 v[44:59], v[140:143], v[36:43], v1
    v_exp_f32 v14, v14
    v_exp_f32 v15, v15
    v_exp_f32 v16, v16
    v_mfma_f32_32x32x16_bf16 v[28:43], v[76:79], v[60:63], 0
    v_exp_f32 v17, v17
    v_exp_f32 v18, v18
    v_exp_f32 v19, v19
    v_exp_f32 v20, v20
    v_exp_f32 v21, v21
    v_exp_f32 v22, v22
    v_exp_f32 v23, v23
    v_exp_f32 v24, v24
    v_exp_f32 v25, v25
    v_exp_f32 v26, v26
    v_smfmac_f32_32x32x32_bf16 v[44:59], v[144:147], v[12:19], v1
    v_exp_f32 v27, v27
    v_exp_f32 v28, v28
    v_exp_f32 v29, v29
    v_smfmac_f32_32x32x32_bf16 v[44:59], v[148:151], v[20:27], v1
    v_exp_f32 v30, v30
    v_exp_f32 v31, v31
    v_exp_f32 v32, v32
    v_mfma_f32_32x32x16_bf16 v[12:27], v[80:83], v[60:63], 0
    v_exp_f32 v33, v33
    v_exp_f32 v34, v34
    v_exp_f32 v35, v35
    v_exp_f32 v36, v36
    v_exp_f32 v37, v37
    v_exp_f32 v38, v38
    v_exp_f32 v39, v39
    v_exp_f32 v40, v40
    v_exp_f32 v41, v41
    v_exp_f32 v42, v42
    v_smfmac_f32_32x32x32_bf16 v[44:59], v[152:155], v[28:35], v1
    v_exp_f32 v43, v43
    v_exp_f32 v12, v12
    v_exp_f32 v13, v13
    v_smfmac_f32_32x32x32_bf16 v[44:59], v[156:159], v[36:43], v1
    v_exp_f32 v14, v14
    v_exp_f32 v15, v15
    v_exp_f32 v16, v16
    v_mfma_f32_32x32x16_bf16 v[28:43], v[84:87], v[60:63], 0
    v_exp_f32 v17, v17
    v_exp_f32 v18, v18
    v_exp_f32 v19, v19
    v_exp_f32 v20, v20
    v_exp_f32 v21, v21
    v_exp_f32 v22, v22
    v_exp_f32 v23, v23
    v_exp_f32 v24, v24
    v_exp_f32 v25, v25
    v_exp_f32 v26, v26
    v_smfmac_f32_32x32x32_bf16 v[44:59], v[160:163], v[12:19], v1
    v_exp_f32 v27, v27
    v_exp_f32 v28, v28
    v_exp_f32 v29, v29
    v_smfmac_f32_32x32x32_bf16 v[44:59], v[164:167], v[20:27], v1
    v_exp_f32 v30, v30
    v_exp_f32 v31, v31
    v_exp_f32 v32, v32
    v_mfma_f32_32x32x16_bf16 v[12:27], v[88:91], v[60:63], 0
    v_exp_f32 v33, v33
    v_exp_f32 v34, v34
    v_exp_f32 v35, v35
    v_exp_f32 v36, v36
    v_exp_f32 v37, v37
    v_exp_f32 v38, v38
    v_exp_f32 v39, v39
    v_exp_f32 v40, v40
    v_exp_f32 v41, v41
    v_exp_f32 v42, v42
    v_smfmac_f32_32x32x32_bf16 v[44:59], v[168:171], v[28:35], v1
    v_exp_f32 v43, v43
    v_exp_f32 v12, v12
    v_exp_f32 v13, v13
    v_smfmac_f32_32x32x32_bf16 v[44:59], v[172:175], v[36:43], v1
    v_exp_f32 v14, v14
    v_exp_f32 v15, v15
    v_exp_f32 v16, v16
    v_mfma_f32_32x32x16_bf16 v[28:43], v[92:95], v[60:63], 0
    v_exp_f32 v17, v17
    v_exp_f32 v18, v18
    v_exp_f32 v19, v19
    v_exp_f32 v20, v20
    v_exp_f32 v21, v21
    v_exp_f32 v22, v22
    v_exp_f32 v23, v23
    v_exp_f32 v24, v24
    v_exp_f32 v25, v25
    v_exp_f32 v26, v26
    v_smfmac_f32_32x32x32_bf16 v[44:59], v[176:179], v[12:19], v1
    v_exp_f32 v27, v27
    v_exp_f32 v28, v28
    v_exp_f32 v29, v29
    v_smfmac_f32_32x32x32_bf16 v[44:59], v[180:183], v[20:27], v1
    v_exp_f32 v30, v30
    v_exp_f32 v31, v31
    v_exp_f32 v32, v32
    v_mfma_f32_32x32x16_bf16 v[12:27], v[96:99], v[60:63], 0
    v_exp_f32 v33, v33
    v_exp_f32 v34, v34
    v_exp_f32 v35, v35
    v_exp_f32 v36, v36
    v_exp_f32 v37, v37
    v_exp_f32 v38, v38
    v_exp_f32 v39, v39
    v_exp_f32 v40, v40
    v_exp_f32 v41, v41
    v_exp_f32 v42, v42
    v_smfmac_f32_32x32x32_bf16 v[44:59], v[184:187], v[28:35], v1
    v_exp_f32 v43, v43
    v_exp_f32 v12, v12
    v_exp_f32 v13, v13
    v_smfmac_f32_32x32x32_bf16 v[44:59], v[188:191], v[36:43], v1
    v_exp_f32 v14, v14
    v_exp_f32 v15, v15
    v_exp_f32 v16, v16
    v_mfma_f32_32x32x16_bf16 v[28:43], v[100:103], v[60:63], 0
    v_exp_f32 v17, v17
    v_exp_f32 v18, v18
    v_exp_f32 v19, v19
    v_exp_f32 v20, v20
    v_exp_f32 v21, v21
    v_exp_f32 v22, v22
    v_exp_f32 v23, v23
    v_exp_f32 v24, v24
    v_exp_f32 v25, v25
    v_exp_f32 v26, v26
    v_smfmac_f32_32x32x32_bf16 v[44:59], v[192:195], v[12:19], v1
    v_exp_f32 v27, v27
    v_exp_f32 v28, v28
    v_exp_f32 v29, v29
    v_smfmac_f32_32x32x32_bf16 v[44:59], v[196:199], v[20:27], v1
    v_exp_f32 v30, v30
    v_exp_f32 v31, v31
    v_exp_f32 v32, v32
    v_mfma_f32_32x32x16_bf16 v[12:27], v[104:107], v[60:63], 0
    v_exp_f32 v33, v33
    v_exp_f32 v34, v34
    v_exp_f32 v35, v35
    v_exp_f32 v36, v36
    v_exp_f32 v37, v37
    v_exp_f32 v38, v38
    v_exp_f32 v39, v39
    v_exp_f32 v40, v40
    v_exp_f32 v41, v41
    v_exp_f32 v42, v42
    v_smfmac_f32_32x32x32_bf16 v[44:59], v[200:203], v[28:35], v1
    v_exp_f32 v43, v43
    v_exp_f32 v12, v12
    v_exp_f32 v13, v13
    v_smfmac_f32_32x32x32_bf16 v[44:59], v[204:207], v[36:43], v1
    v_exp_f32 v14, v14
    v_exp_f32 v15, v15
    v_exp_f32 v16, v16
    v_mfma_f32_32x32x16_bf16 v[28:43], v[108:111], v[60:63], 0
    v_exp_f32 v17, v17
    v_exp_f32 v18, v18
    v_exp_f32 v19, v19
    v_exp_f32 v20, v20
    v_exp_f32 v21, v21
    v_exp_f32 v22, v22
    v_exp_f32 v23, v23
    v_exp_f32 v24, v24
    v_exp_f32 v25, v25
    v_exp_f32 v26, v26
    v_smfmac_f32_32x32x32_bf16 v[44:59], v[208:211], v[12:19], v1
    v_exp_f32 v27, v27
    v_exp_f32 v28, v28
    v_exp_f32 v29, v29
    v_smfmac_f32_32x32x32_bf16 v[44:59], v[212:215], v[20:27], v1
    v_exp_f32 v30, v30
    v_exp_f32 v31, v31
    v_exp_f32 v32, v32
    v_mfma_f32_32x32x16_bf16 v[12:27], v[112:115], v[60:63], 0
    v_exp_f32 v33, v33
    v_exp_f32 v34, v34
    v_exp_f32 v35, v35
    v_exp_f32 v36, v36
    v_exp_f32 v37, v37
    v_exp_f32 v38, v38
    v_exp_f32 v39, v39
    v_exp_f32 v40, v40
    v_exp_f32 v41, v41
    v_exp_f32 v42, v42
    v_smfmac_f32_32x32x32_bf16 v[44:59], v[216:219], v[28:35], v1
    v_exp_f32 v43, v43
    v_exp_f32 v12, v12
    v_exp_f32 v13, v13
    v_smfmac_f32_32x32x32_bf16 v[44:59], v[220:223], v[36:43], v1
    v_exp_f32 v14, v14
    v_exp_f32 v15, v15
    v_exp_f32 v16, v16
    v_mfma_f32_32x32x16_bf16 v[28:43], v[116:119], v[60:63], 0
    v_exp_f32 v17, v17
    v_exp_f32 v18, v18
    v_exp_f32 v19, v19
    v_exp_f32 v20, v20
    v_exp_f32 v21, v21
    v_exp_f32 v22, v22
    v_exp_f32 v23, v23
    v_exp_f32 v24, v24
    v_exp_f32 v25, v25
    v_exp_f32 v26, v26
    v_smfmac_f32_32x32x32_bf16 v[44:59], v[224:227], v[12:19], v1
    v_exp_f32 v27, v27
    v_exp_f32 v28, v28
    v_exp_f32 v29, v29
    v_smfmac_f32_32x32x32_bf16 v[44:59], v[228:231], v[20:27], v1
    v_exp_f32 v30, v30
    v_exp_f32 v31, v31
    v_exp_f32 v32, v32
    v_mfma_f32_32x32x16_bf16 v[12:27], v[120:123], v[60:63], 0
    v_exp_f32 v33, v33
    v_exp_f32 v34, v34
    v_exp_f32 v35, v35
    v_exp_f32 v36, v36
    v_exp_f32 v37, v37
    v_exp_f32 v38, v38
    v_exp_f32 v39, v39
    v_exp_f32 v40, v40
    v_exp_f32 v41, v41
    v_exp_f32 v42, v42
    v_smfmac_f32_32x32x32_bf16 v[44:59], v[232:235], v[28:35], v1
    v_exp_f32 v43, v43
    v_exp_f32 v12, v12
    v_exp_f32 v13, v13
    v_smfmac_f32_32x32x32_bf16 v[44:59], v[236:239], v[36:43], v1
    v_exp_f32 v14, v14
    v_exp_f32 v15, v15
    v_exp_f32 v16, v16
    v_mfma_f32_32x32x16_bf16 v[28:43], v[124:127], v[60:63], 0
    ds_read_b128 v[60:63], v4 offset:4096
    v_exp_f32 v17, v17
    v_exp_f32 v18, v18
    v_exp_f32 v19, v19
    v_exp_f32 v20, v20
    v_exp_f32 v21, v21
    v_exp_f32 v22, v22
    v_exp_f32 v23, v23
    v_exp_f32 v24, v24
    v_exp_f32 v25, v25
    v_exp_f32 v26, v26
    v_smfmac_f32_32x32x32_bf16 v[44:59], v[240:243], v[12:19], v1
    v_exp_f32 v27, v27
    v_exp_f32 v28, v28
    v_exp_f32 v29, v29
    v_smfmac_f32_32x32x32_bf16 v[44:59], v[244:247], v[20:27], v1
    v_exp_f32 v30, v30
    v_exp_f32 v31, v31
    v_exp_f32 v32, v32
    s_waitcnt lgkmcnt(0)
    v_mfma_f32_32x32x16_bf16 v[12:27], v[64:67], v[60:63], 0
    v_exp_f32 v33, v33
    v_exp_f32 v34, v34
    v_exp_f32 v35, v35
    v_exp_f32 v36, v36
    v_exp_f32 v37, v37
    v_exp_f32 v38, v38
    v_exp_f32 v39, v39
    v_exp_f32 v40, v40
    v_exp_f32 v41, v41
    v_exp_f32 v42, v42
    v_smfmac_f32_32x32x32_bf16 v[44:59], v[248:251], v[28:35], v1
    v_exp_f32 v43, v43
    s_branch L_aw_pg4
.p2align 12
L_aw_visit4:
    s_branch L_aw_visit6
    s_nop 0
L_aw_pg4:
    v_exp_f32 v12, v12
    v_exp_f32 v13, v13
    v_smfmac_f32_32x32x32_bf16 v[44:59], v[252:255], v[36:43], v1
    v_exp_f32 v14, v14
    v_exp_f32 v15, v15
    v_exp_f32 v16, v16
    v_mfma_f32_32x32x16_bf16 v[28:43], v[68:71], v[60:63], 0
    v_exp_f32 v17, v17
    v_exp_f32 v18, v18
    v_exp_f32 v19, v19
    v_exp_f32 v20, v20
    v_exp_f32 v21, v21
    v_exp_f32 v22, v22
    ds_write_b128 v5, v[44:47] offset:24576
    v_exp_f32 v23, v23
    v_exp_f32 v24, v24
    ds_write_b128 v5, v[48:51] offset:25600
    v_exp_f32 v25, v25
    v_exp_f32 v26, v26
    ds_write_b32 v6, v52 offset:3072
    v_mfma_f32_32x32x8_bf16 v[44:59], v[2:3], v[2:3], 0
    v_exp_f32 v27, v27
    v_exp_f32 v28, v28
    v_exp_f32 v29, v29
    v_smfmac_f32_32x32x32_bf16 v[44:59], v[128:131], v[12:19], v1
    v_exp_f32 v30, v30
    v_exp_f32 v31, v31
    v_exp_f32 v32, v32
    v_smfmac_f32_32x32x32_bf16 v[44:59], v[132:135], v[20:27], v1
    v_exp_f32 v33, v33
    v_exp_f32 v34, v34
    v_exp_f32 v35, v35
    v_mfma_f32_32x32x16_bf16 v[12:27], v[72:75], v[60:63], 0
    v_exp_f32 v36, v36
    v_exp_f32 v37, v37
    v_exp_f32 v38, v38
    v_exp_f32 v39, v39
    v_exp_f32 v40, v40
    v_exp_f32 v41, v41
    v_exp_f32 v42, v42
    v_smfmac_f32_32x32x32_bf16 v[44:59], v[136:139], v[28:35], v1
    v_exp_f32 v43, v43
    v_exp_f32 v12, v12
    v_exp_f32 v13, v13
    v_smfmac_f32_32x32x32_bf16 v[44:59], v[140:143], v[36:43], v1
    v_exp_f32 v14, v14
    v_exp_f32 v15, v15
    v_exp_f32 v16, v16
    v_mfma_f32_32x32x16_bf16 v[28:43], v[76:79], v[60:63], 0
    v_exp_f32 v17, v17
    v_exp_f32 v18, v18
    v_exp_f32 v19, v19
    v_exp_f32 v20, v20
    v_exp_f32 v21, v21
    v_exp_f32 v22, v22
    v_exp_f32 v23, v23
    v_exp_f32 v24, v24
    v_exp_f32 v25, v25
    v_exp_f32 v26, v26
    v_smfmac_f32_32x32x32_bf16 v[44:59], v[144:147], v[12:19], v1
    v_exp_f32 v27, v27
    v_exp_f32 v28, v28
    v_exp_f32 v29, v29
    v_smfmac_f32_32x32x32_bf16 v[44:59], v[148:151], v[20:27], v1
    v_exp_f32 v30, v30
    v_exp_f32 v31, v31
    v_exp_f32 v32, v32
    v_mfma_f32_32x32x16_bf16 v[12:27], v[80:83], v[60:63], 0
    v_exp_f32 v33, v33
    v_exp_f32 v34, v34
    v_exp_f32 v35, v35
    v_exp_f32 v36, v36
    v_exp_f32 v37, v37
    v_exp_f32 v38, v38
    v_exp_f32 v39, v39
    v_exp_f32 v40, v40
    v_exp_f32 v41, v41
    v_exp_f32 v42, v42
    v_smfmac_f32_32x32x32_bf16 v[44:59], v[152:155], v[28:35], v1
    v_exp_f32 v43, v43
    v_exp_f32 v12, v12
    v_exp_f32 v13, v13
    v_smfmac_f32_32x32x32_bf16 v[44:59], v[156:159], v[36:43], v1
    v_exp_f32 v14, v14
    v_exp_f32 v15, v15
    v_exp_f32 v16, v16
    v_mfma_f32_32x32x16_bf16 v[28:43], v[84:87], v[60:63], 0
    v_exp_f32 v17, v17
    v_exp_f32 v18, v18
    v_exp_f32 v19, v19
    v_exp_f32 v20, v20
    v_exp_f32 v21, v21
    v_exp_f32 v22, v22
    v_exp_f32 v23, v23
    v_exp_f32 v24, v24
    v_exp_f32 v25, v25
    v_exp_f32 v26, v26
    v_smfmac_f32_32x32x32_bf16 v[44:59], v[160:163], v[12:19], v1
    v_exp_f32 v27, v27
    v_exp_f32 v28, v28
    v_exp_f32 v29, v29
    v_smfmac_f32_32x32x32_bf16 v[44:59], v[164:167], v[20:27], v1
    v_exp_f32 v30, v30
    v_exp_f32 v31, v31
    v_exp_f32 v32, v32
    v_mfma_f32_32x32x16_bf16 v[12:27], v[88:91], v[60:63], 0
    v_exp_f32 v33, v33
    v_exp_f32 v34, v34
    v_exp_f32 v35, v35
    v_exp_f32 v36, v36
    v_exp_f32 v37, v37
    v_exp_f32 v38, v38
    v_exp_f32 v39, v39
    v_exp_f32 v40, v40
    v_exp_f32 v41, v41
    v_exp_f32 v42, v42
    v_smfmac_f32_32x32x32_bf16 v[44:59], v[168:171], v[28:35], v1
    v_exp_f32 v43, v43
    v_exp_f32 v12, v12
    v_exp_f32 v13, v13
    v_smfmac_f32_32x32x32_bf16 v[44:59], v[172:175], v[36:43], v1
    v_exp_f32 v14, v14
    v_exp_f32 v15, v15
    v_exp_f32 v16, v16
    v_mfma_f32_32x32x16_bf16 v[28:43], v[92:95], v[60:63], 0
    v_exp_f32 v17, v17
    v_exp_f32 v18, v18
    v_exp_f32 v19, v19
    v_exp_f32 v20, v20
    v_exp_f32 v21, v21
    v_exp_f32 v22, v22
    v_exp_f32 v23, v23
    v_exp_f32 v24, v24
    v_exp_f32 v25, v25
    v_exp_f32 v26, v26
    v_smfmac_f32_32x32x32_bf16 v[44:59], v[176:179], v[12:19], v1
    v_exp_f32 v27, v27
    v_exp_f32 v28, v28
    v_exp_f32 v29, v29
    v_smfmac_f32_32x32x32_bf16 v[44:59], v[180:183], v[20:27], v1
    v_exp_f32 v30, v30
    v_exp_f32 v31, v31
    v_exp_f32 v32, v32
    v_mfma_f32_32x32x16_bf16 v[12:27], v[96:99], v[60:63], 0
    v_exp_f32 v33, v33
    v_exp_f32 v34, v34
    v_exp_f32 v35, v35
    v_exp_f32 v36, v36
    v_exp_f32 v37, v37
    v_exp_f32 v38, v38
    v_exp_f32 v39, v39
    v_exp_f32 v40, v40
    v_exp_f32 v41, v41
    v_exp_f32 v42, v42
    v_smfmac_f32_32x32x32_bf16 v[44:59], v[184:187], v[28:35], v1
    v_exp_f32 v43, v43
    v_exp_f32 v12, v12
    v_exp_f32 v13, v13
    v_smfmac_f32_32x32x32_bf16 v[44:59], v[188:191], v[36:43], v1
    v_exp_f32 v14, v14
    v_exp_f32 v15, v15
    v_exp_f32 v16, v16
    v_mfma_f32_32x32x16_bf16 v[28:43], v[100:103], v[60:63], 0
    v_exp_f32 v17, v17
    v_exp_f32 v18, v18
    v_exp_f32 v19, v19
    v_exp_f32 v20, v20
    v_exp_f32 v21, v21
    v_exp_f32 v22, v22
    v_exp_f32 v23, v23
    v_exp_f32 v24, v24
    v_exp_f32 v25, v25
    v_exp_f32 v26, v26
    v_smfmac_f32_32x32x32_bf16 v[44:59], v[192:195], v[12:19], v1
    v_exp_f32 v27, v27
    v_exp_f32 v28, v28
    v_exp_f32 v29, v29
    v_smfmac_f32_32x32x32_bf16 v[44:59], v[196:199], v[20:27], v1
    v_exp_f32 v30, v30
    v_exp_f32 v31, v31
    v_exp_f32 v32, v32
    v_mfma_f32_32x32x16_bf16 v[12:27], v[104:107], v[60:63], 0
    v_exp_f32 v33, v33
    v_exp_f32 v34, v34
    v_exp_f32 v35, v35
    v_exp_f32 v36, v36
    v_exp_f32 v37, v37
    v_exp_f32 v38, v38
    v_exp_f32 v39, v39
    v_exp_f32 v40, v40
    v_exp_f32 v41, v41
    v_exp_f32 v42, v42
    v_smfmac_f32_32x32x32_bf16 v[44:59], v[200:203], v[28:35], v1
    v_exp_f32 v43, v43
    v_exp_f32 v12, v12
    v_exp_f32 v13, v13
    v_smfmac_f32_32x32x32_bf16 v[44:59], v[204:207], v[36:43], v1
    v_exp_f32 v14, v14
    v_exp_f32 v15, v15
    v_exp_f32 v16, v16
    v_mfma_f32_32x32x16_bf16 v[28:43], v[108:111], v[60:63], 0
    v_exp_f32 v17, v17
    v_exp_f32 v18, v18
    v_exp_f32 v19, v19
    v_exp_f32 v20, v20
    v_exp_f32 v21, v21
    v_exp_f32 v22, v22
    v_exp_f32 v23, v23
    v_exp_f32 v24, v24
    v_exp_f32 v25, v25
    v_exp_f32 v26, v26
    v_smfmac_f32_32x32x32_bf16 v[44:59], v[208:211], v[12:19], v1
    v_exp_f32 v27, v27
    v_exp_f32 v28, v28
    v_exp_f32 v29, v29
    v_smfmac_f32_32x32x32_bf16 v[44:59], v[212:215], v[20:27], v1
    v_exp_f32 v30, v30
    v_exp_f32 v31, v31
    v_exp_f32 v32, v32
    v_mfma_f32_32x32x16_bf16 v[12:27], v[112:115], v[60:63], 0
    v_exp_f32 v33, v33
    v_exp_f32 v34, v34
    v_exp_f32 v35, v35
    v_exp_f32 v36, v36
    v_exp_f32 v37, v37
    v_exp_f32 v38, v38
    v_exp_f32 v39, v39
    v_exp_f32 v40, v40
    v_exp_f32 v41, v41
    v_exp_f32 v42, v42
    v_smfmac_f32_32x32x32_bf16 v[44:59], v[216:219], v[28:35], v1
    v_exp_f32 v43, v43
    v_exp_f32 v12, v12
    v_exp_f32 v13, v13
    v_smfmac_f32_32x32x32_bf16 v[44:59], v[220:223], v[36:43], v1
    v_exp_f32 v14, v14
    v_exp_f32 v15, v15
    v_exp_f32 v16, v16
    v_mfma_f32_32x32x16_bf16 v[28:43], v[116:119], v[60:63], 0
    v_exp_f32 v17, v17
    v_exp_f32 v18, v18
    v_exp_f32 v19, v19
    v_exp_f32 v20, v20
    v_exp_f32 v21, v21
    v_exp_f32 v22, v22
    v_exp_f32 v23, v23
    v_exp_f32 v24, v24
    v_exp_f32 v25, v25
    v_exp_f32 v26, v26
    v_smfmac_f32_32x32x32_bf16 v[44:59], v[224:227], v[12:19], v1
    v_exp_f32 v27, v27
    v_exp_f32 v28, v28
    v_exp_f32 v29, v29
    v_smfmac_f32_32x32x32_bf16 v[44:59], v[228:231], v[20:27], v1
    v_exp_f32 v30, v30
    v_exp_f32 v31, v31
    v_exp_f32 v32, v32
    v_mfma_f32_32x32x16_bf16 v[12:27], v[120:123], v[60:63], 0
    v_exp_f32 v33, v33
    v_exp_f32 v34, v34
    v_exp_f32 v35, v35
    v_exp_f32 v36, v36
    v_exp_f32 v37, v37
    v_exp_f32 v38, v38
    v_exp_f32 v39, v39
    v_exp_f32 v40, v40
    v_exp_f32 v41, v41
    v_exp_f32 v42, v42
    v_smfmac_f32_32x32x32_bf16 v[44:59], v[232:235], v[28:35], v1
    v_exp_f32 v43, v43
    v_exp_f32 v12, v12
    v_exp_f32 v13, v13
    v_smfmac_f32_32x32x32_bf16 v[44:59], v[236:239], v[36:43], v1
    v_exp_f32 v14, v14
    v_exp_f32 v15, v15
    v_exp_f32 v16, v16
    v_mfma_f32_32x32x16_bf16 v[28:43], v[124:127], v[60:63], 0
    ds_read_b128 v[60:63], v4 offset:5120
    ds_read_b32 v8, v7 offset:16
    v_exp_f32 v17, v17
    v_exp_f32 v18, v18
    v_exp_f32 v19, v19
    v_exp_f32 v20, v20
    v_exp_f32 v21, v21
    v_exp_f32 v22, v22
    v_exp_f32 v23, v23
    v_exp_f32 v24, v24
    v_exp_f32 v25, v25
    v_exp_f32 v26, v26
    v_smfmac_f32_32x32x32_bf16 v[44:59], v[240:243], v[12:19], v1
    v_exp_f32 v27, v27
    v_exp_f32 v28, v28
    v_exp_f32 v29, v29
    v_smfmac_f32_32x32x32_bf16 v[44:59], v[244:247], v[20:27], v1
    v_exp_f32 v30, v30
    v_exp_f32 v31, v31
    v_exp_f32 v32, v32
    s_waitcnt lgkmcnt(0)
    v_mfma_f32_32x32x16_bf16 v[12:27], v[64:67], v[60:63], 0
    v_exp_f32 v33, v33
    v_exp_f32 v34, v34
    v_exp_f32 v35, v35
    v_exp_f32 v36, v36
    v_exp_f32 v37, v37
    v_exp_f32 v38, v38
    v_exp_f32 v39, v39
    v_exp_f32 v40, v40
    v_exp_f32 v41, v41
    v_exp_f32 v42, v42
    v_smfmac_f32_32x32x32_bf16 v[44:59], v[248:251], v[28:35], v1
    v_exp_f32 v43, v43
    v_exp_f32 v12, v12
    v_exp_f32 v13, v13
    v_smfmac_f32_32x32x32_bf16 v[44:59], v[252:255], v[36:43], v1
    v_exp_f32 v14, v14
    v_exp_f32 v15, v15
    v_exp_f32 v16, v16
    v_mfma_f32_32x32x16_bf16 v[28:43], v[68:71], v[60:63], 0
    v_exp_f32 v17, v17
    v_cmp_eq_u32 vcc, 0, v8
    v_exp_f32 v18, v18
    v_exp_f32 v19, v19
    v_exp_f32 v20, v20
    v_exp_f32 v21, v21
    v_exp_f32 v22, v22
    s_cbranch_vccnz Lcw_19
Lcwd_20:
    ds_write_b128 v5, v[44:47] offset:0
    v_exp_f32 v23, v23
    v_exp_f32 v24, v24
    ds_write_b128 v5, v[48:51] offset:1024
    v_exp_f32 v25, v25
    v_exp_f32 v26, v26
    ds_write_b32 v6, v52 offset:0
    v_mfma_f32_32x32x8_bf16 v[44:59], v[2:3], v[2:3], 0
    v_exp_f32 v27, v27
    v_exp_f32 v28, v28
    v_exp_f32 v29, v29
    v_smfmac_f32_32x32x32_bf16 v[44:59], v[128:131], v[12:19], v1
    v_exp_f32 v30, v30
    v_exp_f32 v31, v31
    v_exp_f32 v32, v32
    v_smfmac_f32_32x32x32_bf16 v[44:59], v[132:135], v[20:27], v1
    v_exp_f32 v33, v33
    v_exp_f32 v34, v34
    v_exp_f32 v35, v35
    v_mfma_f32_32x32x16_bf16 v[12:27], v[72:75], v[60:63], 0
    v_exp_f32 v36, v36
    v_exp_f32 v37, v37
    v_exp_f32 v38, v38
    v_exp_f32 v39, v39
    v_exp_f32 v40, v40
    v_exp_f32 v41, v41
    v_exp_f32 v42, v42
    v_smfmac_f32_32x32x32_bf16 v[44:59], v[136:139], v[28:35], v1
    v_exp_f32 v43, v43
    v_exp_f32 v12, v12
    v_exp_f32 v13, v13
    v_smfmac_f32_32x32x32_bf16 v[44:59], v[140:143], v[36:43], v1
    v_exp_f32 v14, v14
    v_exp_f32 v15, v15
    v_exp_f32 v16, v16
    v_mfma_f32_32x32x16_bf16 v[28:43], v[76:79], v[60:63], 0
    v_exp_f32 v17, v17
    v_exp_f32 v18, v18
    v_exp_f32 v19, v19
    v_exp_f32 v20, v20
    v_exp_f32 v21, v21
    v_exp_f32 v22, v22
    v_exp_f32 v23, v23
    v_exp_f32 v24, v24
    v_exp_f32 v25, v25
    v_exp_f32 v26, v26
    v_smfmac_f32_32x32x32_bf16 v[44:59], v[144:147], v[12:19], v1
    v_exp_f32 v27, v27
    v_exp_f32 v28, v28
    v_exp_f32 v29, v29
    v_smfmac_f32_32x32x32_bf16 v[44:59], v[148:151], v[20:27], v1
    v_exp_f32 v30, v30
    v_exp_f32 v31, v31
    v_exp_f32 v32, v32
    v_mfma_f32_32x32x16_bf16 v[12:27], v[80:83], v[60:63], 0
    v_exp_f32 v33, v33
    v_exp_f32 v34, v34
    v_exp_f32 v35, v35
    v_exp_f32 v36, v36
    v_exp_f32 v37, v37
    v_exp_f32 v38, v38
    v_exp_f32 v39, v39
    v_exp_f32 v40, v40
    v_exp_f32 v41, v41
    v_exp_f32 v42, v42
    v_smfmac_f32_32x32x32_bf16 v[44:59], v[152:155], v[28:35], v1
    v_exp_f32 v43, v43
    v_exp_f32 v12, v12
    v_exp_f32 v13, v13
    v_smfmac_f32_32x32x32_bf16 v[44:59], v[156:159], v[36:43], v1
    v_exp_f32 v14, v14
    v_exp_f32 v15, v15
    v_exp_f32 v16, v16
    v_mfma_f32_32x32x16_bf16 v[28:43], v[84:87], v[60:63], 0
    v_exp_f32 v17, v17
    v_exp_f32 v18, v18
    v_exp_f32 v19, v19
    v_exp_f32 v20, v20
    v_exp_f32 v21, v21
    v_exp_f32 v22, v22
    v_exp_f32 v23, v23
    v_exp_f32 v24, v24
    v_exp_f32 v25, v25
    v_exp_f32 v26, v26
    v_smfmac_f32_32x32x32_bf16 v[44:59], v[160:163], v[12:19], v1
    v_exp_f32 v27, v27
    v_exp_f32 v28, v28
    v_exp_f32 v29, v29
    v_smfmac_f32_32x32x32_bf16 v[44:59], v[164:167], v[20:27], v1
    v_exp_f32 v30, v30
    v_exp_f32 v31, v31
    v_exp_f32 v32, v32
    v_mfma_f32_32x32x16_bf16 v[12:27], v[88:91], v[60:63], 0
    v_exp_f32 v33, v33
    v_exp_f32 v34, v34
    v_exp_f32 v35, v35
    v_exp_f32 v36, v36
    v_exp_f32 v37, v37
    v_exp_f32 v38, v38
    v_exp_f32 v39, v39
    v_exp_f32 v40, v40
    v_exp_f32 v41, v41
    v_exp_f32 v42, v42
    v_smfmac_f32_32x32x32_bf16 v[44:59], v[168:171], v[28:35], v1
    v_exp_f32 v43, v43
    v_exp_f32 v12, v12
    v_exp_f32 v13, v13
    v_smfmac_f32_32x32x32_bf16 v[44:59], v[172:175], v[36:43], v1
    v_exp_f32 v14, v14
    v_exp_f32 v15, v15
    v_exp_f32 v16, v16
    v_mfma_f32_32x32x16_bf16 v[28:43], v[92:95], v[60:63], 0
    v_exp_f32 v17, v17
    v_exp_f32 v18, v18
    v_exp_f32 v19, v19
    v_exp_f32 v20, v20
    v_exp_f32 v21, v21
    v_exp_f32 v22, v22
    v_exp_f32 v23, v23
    v_exp_f32 v24, v24
    v_exp_f32 v25, v25
    v_exp_f32 v26, v26
    v_smfmac_f32_32x32x32_bf16 v[44:59], v[176:179], v[12:19], v1
    v_exp_f32 v27, v27
    v_exp_f32 v28, v28
    v_exp_f32 v29, v29
    v_smfmac_f32_32x32x32_bf16 v[44:59], v[180:183], v[20:27], v1
    v_exp_f32 v30, v30
    v_exp_f32 v31, v31
    v_exp_f32 v32, v32
    v_mfma_f32_32x32x16_bf16 v[12:27], v[96:99], v[60:63], 0
    v_exp_f32 v33, v33
    v_exp_f32 v34, v34
    v_exp_f32 v35, v35
    v_exp_f32 v36, v36
    v_exp_f32 v37, v37
    v_exp_f32 v38, v38
    v_exp_f32 v39, v39
    v_exp_f32 v40, v40
    v_exp_f32 v41, v41
    v_exp_f32 v42, v42
    v_smfmac_f32_32x32x32_bf16 v[44:59], v[184:187], v[28:35], v1
    v_exp_f32 v43, v43
    v_exp_f32 v12, v12
    v_exp_f32 v13, v13
    v_smfmac_f32_32x32x32_bf16 v[44:59], v[188:191], v[36:43], v1
    v_exp_f32 v14, v14
    v_exp_f32 v15, v15
    v_exp_f32 v16, v16
    v_mfma_f32_32x32x16_bf16 v[28:43], v[100:103], v[60:63], 0
    v_exp_f32 v17, v17
    v_exp_f32 v18, v18
    v_exp_f32 v19, v19
    v_exp_f32 v20, v20
    v_exp_f32 v21, v21
    v_exp_f32 v22, v22
    v_exp_f32 v23, v23
    v_exp_f32 v24, v24
    v_exp_f32 v25, v25
    v_exp_f32 v26, v26
    v_smfmac_f32_32x32x32_bf16 v[44:59], v[192:195], v[12:19], v1
    v_exp_f32 v27, v27
    v_exp_f32 v28, v28
    v_exp_f32 v29, v29
    v_smfmac_f32_32x32x32_bf16 v[44:59], v[196:199], v[20:27], v1
    v_exp_f32 v30, v30
    v_exp_f32 v31, v31
    v_exp_f32 v32, v32
    v_mfma_f32_32x32x16_bf16 v[12:27], v[104:107], v[60:63], 0
    v_exp_f32 v33, v33
    v_exp_f32 v34, v34
    v_exp_f32 v35, v35
    v_exp_f32 v36, v36
    v_exp_f32 v37, v37
    v_exp_f32 v38, v38
    v_exp_f32 v39, v39
    v_exp_f32 v40, v40
    v_exp_f32 v41, v41
    v_exp_f32 v42, v42
    v_smfmac_f32_32x32x32_bf16 v[44:59], v[200:203], v[28:35], v1
    v_exp_f32 v43, v43
    v_exp_f32 v12, v12
    v_exp_f32 v13, v13
    v_smfmac_f32_32x32x32_bf16 v[44:59], v[204:207], v[36:43], v1
    v_exp_f32 v14, v14
    v_exp_f32 v15, v15
    v_exp_f32 v16, v16
    v_mfma_f32_32x32x16_bf16 v[28:43], v[108:111], v[60:63], 0
    v_exp_f32 v17, v17
    v_exp_f32 v18, v18
    v_exp_f32 v19, v19
    v_exp_f32 v20, v20
    v_exp_f32 v21, v21
    v_exp_f32 v22, v22
    v_exp_f32 v23, v23
    v_exp_f32 v24, v24
    v_exp_f32 v25, v25
    v_exp_f32 v26, v26
    v_smfmac_f32_32x32x32_bf16 v[44:59], v[208:211], v[12:19], v1
    v_exp_f32 v27, v27
    v_exp_f32 v28, v28
    v_exp_f32 v29, v29
    v_smfmac_f32_32x32x32_bf16 v[44:59], v[212:215], v[20:27], v1
    v_exp_f32 v30, v30
    v_exp_f32 v31, v31
    v_exp_f32 v32, v32
    v_mfma_f32_32x32x16_bf16 v[12:27], v[112:115], v[60:63], 0
    v_exp_f32 v33, v33
    v_exp_f32 v34, v34
    v_exp_f32 v35, v35
    v_exp_f32 v36, v36
    v_exp_f32 v37, v37
    v_exp_f32 v38, v38
    v_exp_f32 v39, v39
    v_exp_f32 v40, v40
    v_exp_f32 v41, v41
    v_exp_f32 v42, v42
    v_smfmac_f32_32x32x32_bf16 v[44:59], v[216:219], v[28:35], v1
    v_exp_f32 v43, v43
    v_exp_f32 v12, v12
    v_exp_f32 v13, v13
    v_smfmac_f32_32x32x32_bf16 v[44:59], v[220:223], v[36:43], v1
    v_exp_f32 v14, v14
    v_exp_f32 v15, v15
    v_exp_f32 v16, v16
    v_mfma_f32_32x32x16_bf16 v[28:43], v[116:119], v[60:63], 0
    v_exp_f32 v17, v17
    v_exp_f32 v18, v18
    v_exp_f32 v19, v19
    v_exp_f32 v20, v20
    v_exp_f32 v21, v21
    v_exp_f32 v22, v22
    v_exp_f32 v23, v23
    v_exp_f32 v24, v24
    v_exp_f32 v25, v25
    v_exp_f32 v26, v26
    v_smfmac_f32_32x32x32_bf16 v[44:59], v[224:227], v[12:19], v1
    v_exp_f32 v27, v27
    v_exp_f32 v28, v28
    v_exp_f32 v29, v29
    v_smfmac_f32_32x32x32_bf16 v[44:59], v[228:231], v[20:27], v1
    v_exp_f32 v30, v30
    v_exp_f32 v31, v31
    v_exp_f32 v32, v32
    v_mfma_f32_32x32x16_bf16 v[12:27], v[120:123], v[60:63], 0
    v_exp_f32 v33, v33
    v_exp_f32 v34, v34
    v_exp_f32 v35, v35
    v_exp_f32 v36, v36
    v_exp_f32 v37, v37
    v_exp_f32 v38, v38
    v_exp_f32 v39, v39
    v_exp_f32 v40, v40
    v_exp_f32 v41, v41
    v_exp_f32 v42, v42
    v_smfmac_f32_32x32x32_bf16 v[44:59], v[232:235], v[28:35], v1
    v_exp_f32 v43, v43
    v_exp_f32 v12, v12
    v_exp_f32 v13, v13
    v_smfmac_f32_32x32x32_bf16 v[44:59], v[236:239], v[36:43], v1
    v_exp_f32 v14, v14
    v_exp_f32 v15, v15
    v_exp_f32 v16, v16
    v_mfma_f32_32x32x16_bf16 v[28:43], v[124:127], v[60:63], 0
    ds_read_b128 v[60:63], v4 offset:6144
    ds_read_b32 v8, v7 offset:20
    v_exp_f32 v17, v17
    v_exp_f32 v18, v18
    v_exp_f32 v19, v19
    v_exp_f32 v20, v20
    v_exp_f32 v21, v21
    v_exp_f32 v22, v22
    v_exp_f32 v23, v23
    v_exp_f32 v24, v24
    v_exp_f32 v25, v25
    v_exp_f32 v26, v26
    v_smfmac_f32_32x32x32_bf16 v[44:59], v[240:243], v[12:19], v1
    v_exp_f32 v27, v27
    v_exp_f32 v28, v28
    v_exp_f32 v29, v29
    v_smfmac_f32_32x32x32_bf16 v[44:59], v[244:247], v[20:27], v1
    v_exp_f32 v30, v30
    v_exp_f32 v31, v31
    v_exp_f32 v32, v32
    s_waitcnt lgkmcnt(0)
    v_mfma_f32_32x32x16_bf16 v[12:27], v[64:67], v[60:63], 0
    v_exp_f32 v33, v33
    v_exp_f32 v34, v34
    v_exp_f32 v35, v35
    v_exp_f32 v36, v36
    v_exp_f32 v37, v37
    v_exp_f32 v38, v38
    v_exp_f32 v39, v39
    v_exp_f32 v40, v40
    v_exp_f32 v41, v41
    v_exp_f32 v42, v42
    v_smfmac_f32_32x32x32_bf16 v[44:59], v[248:251], v[28:35], v1
    v_exp_f32 v43, v43
    s_branch L_aw_pg6
Lcw_19:
    s_cmp_eq_u32 s77, 0
    s_cbranch_scc1 Lcwd_20
    s_sub_u32 s77, s77, 1
    s_sleep 1
    ds_read_b32 v8, v7 offset:16
    s_waitcnt lgkmcnt(0)
    v_cmp_eq_u32 vcc, 0, v8
    s_cbranch_vccnz Lcw_19
    s_branch Lcwd_20
.p2align 12
L_aw_visit6:
    s_branch L_aw_back
    s_nop 0
L_aw_pg6:
    v_exp_f32 v12, v12
    v_exp_f32 v13, v13
    v_smfmac_f32_32x32x32_bf16 v[44:59], v[252:255], v[36:43], v1
    v_exp_f32 v14, v14
    v_exp_f32 v15, v15
    v_exp_f32 v16, v16
    v_mfma_f32_32x32x16_bf16 v[28:43], v[68:71], v[60:63], 0
    v_exp_f32 v17, v17
    v_cmp_eq_u32 vcc, 0, v8
    v_exp_f32 v18, v18
    v_exp_f32 v19, v19
    v_exp_f32 v20, v20
    v_exp_f32 v21, v21
    v_exp_f32 v22, v22
    s_cbranch_vccnz Lcw_21
Lcwd_22:
    ds_write_b128 v5, v[44:47] offset:8192
    v_exp_f32 v23, v23
    v_exp_f32 v24, v24
    ds_write_b128 v5, v[48:51] offset:9216
    v_exp_f32 v25, v25
    v_exp_f32 v26, v26
    ds_write_b32 v6, v52 offset:1024
    v_mfma_f32_32x32x8_bf16 v[44:59], v[2:3], v[2:3], 0
    v_exp_f32 v27, v27
    v_exp_f32 v28, v28
    v_exp_f32 v29, v29
    v_smfmac_f32_32x32x32_bf16 v[44:59], v[128:131], v[12:19], v1
    v_exp_f32 v30, v30
    v_exp_f32 v31, v31
    v_exp_f32 v32, v32
    v_smfmac_f32_32x32x32_bf16 v[44:59], v[132:135], v[20:27], v1
    v_exp_f32 v33, v33
    v_exp_f32 v34, v34
    v_exp_f32 v35, v35
    v_mfma_f32_32x32x16_bf16 v[12:27], v[72:75], v[60:63], 0
    v_exp_f32 v36, v36
    v_exp_f32 v37, v37
    v_exp_f32 v38, v38
    v_exp_f32 v39, v39
    v_exp_f32 v40, v40
    v_exp_f32 v41, v41
    v_exp_f32 v42, v42
    v_smfmac_f32_32x32x32_bf16 v[44:59], v[136:139], v[28:35], v1
    v_exp_f32 v43, v43
    v_exp_f32 v12, v12
    v_exp_f32 v13, v13
    v_smfmac_f32_32x32x32_bf16 v[44:59], v[140:143], v[36:43], v1
    v_exp_f32 v14, v14
    v_exp_f32 v15, v15
    v_exp_f32 v16, v16
    v_mfma_f32_32x32x16_bf16 v[28:43], v[76:79], v[60:63], 0
    v_exp_f32 v17, v17
    v_exp_f32 v18, v18
    v_exp_f32 v19, v19
    v_exp_f32 v20, v20
    v_exp_f32 v21, v21
    v_exp_f32 v22, v22
    v_exp_f32 v23, v23
    v_exp_f32 v24, v24
    v_exp_f32 v25, v25
    v_exp_f32 v26, v26
    v_smfmac_f32_32x32x32_bf16 v[44:59], v[144:147], v[12:19], v1
    v_exp_f32 v27, v27
    v_exp_f32 v28, v28
    v_exp_f32 v29, v29
    v_smfmac_f32_32x32x32_bf16 v[44:59], v[148:151], v[20:27], v1
    v_exp_f32 v30, v30
    v_exp_f32 v31, v31
    v_exp_f32 v32, v32
    v_mfma_f32_32x32x16_bf16 v[12:27], v[80:83], v[60:63], 0
    v_exp_f32 v33, v33
    v_exp_f32 v34, v34
    v_exp_f32 v35, v35
    v_exp_f32 v36, v36
    v_exp_f32 v37, v37
    v_exp_f32 v38, v38
    v_exp_f32 v39, v39
    v_exp_f32 v40, v40
    v_exp_f32 v41, v41
    v_exp_f32 v42, v42
    v_smfmac_f32_32x32x32_bf16 v[44:59], v[152:155], v[28:35], v1
    v_exp_f32 v43, v43
    v_exp_f32 v12, v12
    v_exp_f32 v13, v13
    v_smfmac_f32_32x32x32_bf16 v[44:59], v[156:159], v[36:43], v1
    v_exp_f32 v14, v14
    v_exp_f32 v15, v15
    v_exp_f32 v16, v16
    v_mfma_f32_32x32x16_bf16 v[28:43], v[84:87], v[60:63], 0
    v_exp_f32 v17, v17
    v_exp_f32 v18, v18
    v_exp_f32 v19, v19
    v_exp_f32 v20, v20
    v_exp_f32 v21, v21
    v_exp_f32 v22, v22
    v_exp_f32 v23, v23
    v_exp_f32 v24, v24
    v_exp_f32 v25, v25
    v_exp_f32 v26, v26
    v_smfmac_f32_32x32x32_bf16 v[44:59], v[160:163], v[12:19], v1
    v_exp_f32 v27, v27
    v_exp_f32 v28, v28
    v_exp_f32 v29, v29
    v_smfmac_f32_32x32x32_bf16 v[44:59], v[164:167], v[20:27], v1
    v_exp_f32 v30, v30
    v_exp_f32 v31, v31
    v_exp_f32 v32, v32
    v_mfma_f32_32x32x16_bf16 v[12:27], v[88:91], v[60:63], 0
    v_exp_f32 v33, v33
    v_exp_f32 v34, v34
    v_exp_f32 v35, v35
    v_exp_f32 v36, v36
    v_exp_f32 v37, v37
    v_exp_f32 v38, v38
    v_exp_f32 v39, v39
    v_exp_f32 v40, v40
    v_exp_f32 v41, v41
    v_exp_f32 v42, v42
    v_smfmac_f32_32x32x32_bf16 v[44:59], v[168:171], v[28:35], v1
    v_exp_f32 v43, v43
    v_exp_f32 v12, v12
    v_exp_f32 v13, v13
    v_smfmac_f32_32x32x32_bf16 v[44:59], v[172:175], v[36:43], v1
    v_exp_f32 v14, v14
    v_exp_f32 v15, v15
    v_exp_f32 v16, v16
    v_mfma_f32_32x32x16_bf16 v[28:43], v[92:95], v[60:63], 0
    v_exp_f32 v17, v17
    v_exp_f32 v18, v18
    v_exp_f32 v19, v19
    v_exp_f32 v20, v20
    v_exp_f32 v21, v21
    v_exp_f32 v22, v22
    v_exp_f32 v23, v23
    v_exp_f32 v24, v24
    v_exp_f32 v25, v25
    v_exp_f32 v26, v26
    v_smfmac_f32_32x32x32_bf16 v[44:59], v[176:179], v[12:19], v1
    v_exp_f32 v27, v27
    v_exp_f32 v28, v28
    v_exp_f32 v29, v29
    v_smfmac_f32_32x32x32_bf16 v[44:59], v[180:183], v[20:27], v1
    v_exp_f32 v30, v30
    v_exp_f32 v31, v31
    v_exp_f32 v32, v32
    v_mfma_f32_32x32x16_bf16 v[12:27], v[96:99], v[60:63], 0
    v_exp_f32 v33, v33
    v_exp_f32 v34, v34
    v_exp_f32 v35, v35
    v_exp_f32 v36, v36
    v_exp_f32 v37, v37
    v_exp_f32 v38, v38
    v_exp_f32 v39, v39
    v_exp_f32 v40, v40
    v_exp_f32 v41, v41
    v_exp_f32 v42, v42
    v_smfmac_f32_32x32x32_bf16 v[44:59], v[184:187], v[28:35], v1
    v_exp_f32 v43, v43
    v_exp_f32 v12, v12
    v_exp_f32 v13, v13
    v_smfmac_f32_32x32x32_bf16 v[44:59], v[188:191], v[36:43], v1
    v_exp_f32 v14, v14
    v_exp_f32 v15, v15
    v_exp_f32 v16, v16
    v_mfma_f32_32x32x16_bf16 v[28:43], v[100:103], v[60:63], 0
    v_exp_f32 v17, v17
    v_exp_f32 v18, v18
    v_exp_f32 v19, v19
    v_exp_f32 v20, v20
    v_exp_f32 v21, v21
    v_exp_f32 v22, v22
    v_exp_f32 v23, v23
    v_exp_f32 v24, v24
    v_exp_f32 v25, v25
    v_exp_f32 v26, v26
    v_smfmac_f32_32x32x32_bf16 v[44:59], v[192:195], v[12:19], v1
    v_exp_f32 v27, v27
    v_exp_f32 v28, v28
    v_exp_f32 v29, v29
    v_smfmac_f32_32x32x32_bf16 v[44:59], v[196:199], v[20:27], v1
    v_exp_f32 v30, v30
    v_exp_f32 v31, v31
    v_exp_f32 v32, v32
    v_mfma_f32_32x32x16_bf16 v[12:27], v[104:107], v[60:63], 0
    v_exp_f32 v33, v33
    v_exp_f32 v34, v34
    v_exp_f32 v35, v35
    v_exp_f32 v36, v36
    v_exp_f32 v37, v37
    v_exp_f32 v38, v38
    v_exp_f32 v39, v39
    v_exp_f32 v40, v40
    v_exp_f32 v41, v41
    v_exp_f32 v42, v42
    v_smfmac_f32_32x32x32_bf16 v[44:59], v[200:203], v[28:35], v1
    v_exp_f32 v43, v43
    v_exp_f32 v12, v12
    v_exp_f32 v13, v13
    v_smfmac_f32_32x32x32_bf16 v[44:59], v[204:207], v[36:43], v1
    v_exp_f32 v14, v14
    v_exp_f32 v15, v15
    v_exp_f32 v16, v16
    v_mfma_f32_32x32x16_bf16 v[28:43], v[108:111], v[60:63], 0
    v_exp_f32 v17, v17
    v_exp_f32 v18, v18
    v_exp_f32 v19, v19
    v_exp_f32 v20, v20
    v_exp_f32 v21, v21
    v_exp_f32 v22, v22
    v_exp_f32 v23, v23
    v_exp_f32 v24, v24
    v_exp_f32 v25, v25
    v_exp_f32 v26, v26
    v_smfmac_f32_32x32x32_bf16 v[44:59], v[208:211], v[12:19], v1
    v_exp_f32 v27, v27
    v_exp_f32 v28, v28
    v_exp_f32 v29, v29
    v_smfmac_f32_32x32x32_bf16 v[44:59], v[212:215], v[20:27], v1
    v_exp_f32 v30, v30
    v_exp_f32 v31, v31
    v_exp_f32 v32, v32
    v_mfma_f32_32x32x16_bf16 v[12:27], v[112:115], v[60:63], 0
    v_exp_f32 v33, v33
    v_exp_f32 v34, v34
    v_exp_f32 v35, v35
    v_exp_f32 v36, v36
    v_exp_f32 v37, v37
    v_exp_f32 v38, v38
    v_exp_f32 v39, v39
    v_exp_f32 v40, v40
    v_exp_f32 v41, v41
    v_exp_f32 v42, v42
    v_smfmac_f32_32x32x32_bf16 v[44:59], v[216:219], v[28:35], v1
    v_exp_f32 v43, v43
    v_exp_f32 v12, v12
    v_exp_f32 v13, v13
    v_smfmac_f32_32x32x32_bf16 v[44:59], v[220:223], v[36:43], v1
    v_exp_f32 v14, v14
    v_exp_f32 v15, v15
    v_exp_f32 v16, v16
    v_mfma_f32_32x32x16_bf16 v[28:43], v[116:119], v[60:63], 0
    v_exp_f32 v17, v17
    v_exp_f32 v18, v18
    v_exp_f32 v19, v19
    v_exp_f32 v20, v20
    v_exp_f32 v21, v21
    v_exp_f32 v22, v22
    v_exp_f32 v23, v23
    v_exp_f32 v24, v24
    v_exp_f32 v25, v25
    v_exp_f32 v26, v26
    v_smfmac_f32_32x32x32_bf16 v[44:59], v[224:227], v[12:19], v1
    v_exp_f32 v27, v27
    v_exp_f32 v28, v28
    v_exp_f32 v29, v29
    v_smfmac_f32_32x32x32_bf16 v[44:59], v[228:231], v[20:27], v1
    v_exp_f32 v30, v30
    v_exp_f32 v31, v31
    v_exp_f32 v32, v32
    v_mfma_f32_32x32x16_bf16 v[12:27], v[120:123], v[60:63], 0
    v_exp_f32 v33, v33
    v_exp_f32 v34, v34
    v_exp_f32 v35, v35
    v_exp_f32 v36, v36
    v_exp_f32 v37, v37
    v_exp_f32 v38, v38
    v_exp_f32 v39, v39
    v_exp_f32 v40, v40
    v_exp_f32 v41, v41
    v_exp_f32 v42, v42
    v_smfmac_f32_32x32x32_bf16 v[44:59], v[232:235], v[28:35], v1
    v_exp_f32 v43, v43
    v_exp_f32 v12, v12
    v_exp_f32 v13, v13
    v_smfmac_f32_32x32x32_bf16 v[44:59], v[236:239], v[36:43], v1
    v_exp_f32 v14, v14
    v_exp_f32 v15, v15
    v_exp_f32 v16, v16
    v_mfma_f32_32x32x16_bf16 v[28:43], v[124:127], v[60:63], 0
    ds_read_b128 v[60:63], v4 offset:7168
    ds_read_b32 v8, v7 offset:24
    v_exp_f32 v17, v17
    v_exp_f32 v18, v18
    v_exp_f32 v19, v19
    v_exp_f32 v20, v20
    v_exp_f32 v21, v21
    v_exp_f32 v22, v22
    v_exp_f32 v23, v23
    v_exp_f32 v24, v24
    v_exp_f32 v25, v25
    v_exp_f32 v26, v26
    v_smfmac_f32_32x32x32_bf16 v[44:59], v[240:243], v[12:19], v1
    v_exp_f32 v27, v27
    v_exp_f32 v28, v28
    v_exp_f32 v29, v29
    v_smfmac_f32_32x32x32_bf16 v[44:59], v[244:247], v[20:27], v1
    v_exp_f32 v30, v30
    v_exp_f32 v31, v31
    v_exp_f32 v32, v32
    s_waitcnt lgkmcnt(0)
    v_mfma_f32_32x32x16_bf16 v[12:27], v[64:67], v[60:63], 0
    v_exp_f32 v33, v33
    v_exp_f32 v34, v34
    v_exp_f32 v35, v35
    v_exp_f32 v36, v36
    v_exp_f32 v37, v37
    v_exp_f32 v38, v38
    v_exp_f32 v39, v39
    v_exp_f32 v40, v40
    v_exp_f32 v41, v41
    v_exp_f32 v42, v42
    v_smfmac_f32_32x32x32_bf16 v[44:59], v[248:251], v[28:35], v1
    v_exp_f32 v43, v43
    v_exp_f32 v12, v12
    v_exp_f32 v13, v13
    v_smfmac_f32_32x32x32_bf16 v[44:59], v[252:255], v[36:43], v1
    v_exp_f32 v14, v14
    v_exp_f32 v15, v15
    v_exp_f32 v16, v16
    v_mfma_f32_32x32x16_bf16 v[28:43], v[68:71], v[60:63], 0
    v_exp_f32 v17, v17
    v_cmp_eq_u32 vcc, 0, v8
    v_exp_f32 v18, v18
    v_exp_f32 v19, v19
    v_exp_f32 v20, v20
    v_exp_f32 v21, v21
    v_exp_f32 v22, v22
    s_cbranch_vccnz Lcw_23
Lcwd_24:
    ds_write_b128 v5, v[44:47] offset:16384
    v_exp_f32 v23, v23
    v_exp_f32 v24, v24
    ds_write_b128 v5, v[48:51] offset:17408
    v_exp_f32 v25, v25
    v_exp_f32 v26, v26
    ds_write_b32 v6, v52 offset:2048
    v_mfma_f32_32x32x8_bf16 v[44:59], v[2:3], v[2:3], 0
    v_exp_f32 v27, v27
    v_exp_f32 v28, v28
    v_exp_f32 v29, v29
    v_smfmac_f32_32x32x32_bf16 v[44:59], v[128:131], v[12:19], v1
    v_exp_f32 v30, v30
    v_exp_f32 v31, v31
    v_exp_f32 v32, v32
    v_smfmac_f32_32x32x32_bf16 v[44:59], v[132:135], v[20:27], v1
    v_exp_f32 v33, v33
    v_exp_f32 v34, v34
    v_exp_f32 v35, v35
    v_mfma_f32_32x32x16_bf16 v[12:27], v[72:75], v[60:63], 0
    v_exp_f32 v36, v36
    v_exp_f32 v37, v37
    v_exp_f32 v38, v38
    v_exp_f32 v39, v39
    v_exp_f32 v40, v40
    v_exp_f32 v41, v41
    v_exp_f32 v42, v42
    v_smfmac_f32_32x32x32_bf16 v[44:59], v[136:139], v[28:35], v1
    v_exp_f32 v43, v43
    v_exp_f32 v12, v12
    v_exp_f32 v13, v13
    v_smfmac_f32_32x32x32_bf16 v[44:59], v[140:143], v[36:43], v1
    v_exp_f32 v14, v14
    v_exp_f32 v15, v15
    v_exp_f32 v16, v16
    v_mfma_f32_32x32x16_bf16 v[28:43], v[76:79], v[60:63], 0
    v_exp_f32 v17, v17
    v_exp_f32 v18, v18
    v_exp_f32 v19, v19
    v_exp_f32 v20, v20
    v_exp_f32 v21, v21
    v_exp_f32 v22, v22
    v_exp_f32 v23, v23
    v_exp_f32 v24, v24
    v_exp_f32 v25, v25
    v_exp_f32 v26, v26
    v_smfmac_f32_32x32x32_bf16 v[44:59], v[144:147], v[12:19], v1
    v_exp_f32 v27, v27
    v_exp_f32 v28, v28
    v_exp_f32 v29, v29
    v_smfmac_f32_32x32x32_bf16 v[44:59], v[148:151], v[20:27], v1
    v_exp_f32 v30, v30
    v_exp_f32 v31, v31
    v_exp_f32 v32, v32
    v_mfma_f32_32x32x16_bf16 v[12:27], v[80:83], v[60:63], 0
    v_exp_f32 v33, v33
    v_exp_f32 v34, v34
    v_exp_f32 v35, v35
    v_exp_f32 v36, v36
    v_exp_f32 v37, v37
    v_exp_f32 v38, v38
    v_exp_f32 v39, v39
    v_exp_f32 v40, v40
    v_exp_f32 v41, v41
    v_exp_f32 v42, v42
    v_smfmac_f32_32x32x32_bf16 v[44:59], v[152:155], v[28:35], v1
    v_exp_f32 v43, v43
    v_exp_f32 v12, v12
    v_exp_f32 v13, v13
    v_smfmac_f32_32x32x32_bf16 v[44:59], v[156:159], v[36:43], v1
    v_exp_f32 v14, v14
    v_exp_f32 v15, v15
    v_exp_f32 v16, v16
    v_mfma_f32_32x32x16_bf16 v[28:43], v[84:87], v[60:63], 0
    v_exp_f32 v17, v17
    v_exp_f32 v18, v18
    v_exp_f32 v19, v19
    v_exp_f32 v20, v20
    v_exp_f32 v21, v21
    v_exp_f32 v22, v22
    v_exp_f32 v23, v23
    v_exp_f32 v24, v24
    v_exp_f32 v25, v25
    v_exp_f32 v26, v26
    v_smfmac_f32_32x32x32_bf16 v[44:59], v[160:163], v[12:19], v1
    v_exp_f32 v27, v27
    v_exp_f32 v28, v28
    v_exp_f32 v29, v29
    v_smfmac_f32_32x32x32_bf16 v[44:59], v[164:167], v[20:27], v1
    v_exp_f32 v30, v30
    v_exp_f32 v31, v31
    v_exp_f32 v32, v32
    v_mfma_f32_32x32x16_bf16 v[12:27], v[88:91], v[60:63], 0
    v_exp_f32 v33, v33
    v_exp_f32 v34, v34
    v_exp_f32 v35, v35
    v_exp_f32 v36, v36
    v_exp_f32 v37, v37
    v_exp_f32 v38, v38
    v_exp_f32 v39, v39
    v_exp_f32 v40, v40
    v_exp_f32 v41, v41
    v_exp_f32 v42, v42
    v_smfmac_f32_32x32x32_bf16 v[44:59], v[168:171], v[28:35], v1
    v_exp_f32 v43, v43
    v_exp_f32 v12, v12
    v_exp_f32 v13, v13
    v_smfmac_f32_32x32x32_bf16 v[44:59], v[172:175], v[36:43], v1
    v_exp_f32 v14, v14
    v_exp_f32 v15, v15
    v_exp_f32 v16, v16
    v_mfma_f32_32x32x16_bf16 v[28:43], v[92:95], v[60:63], 0
    v_exp_f32 v17, v17
    v_exp_f32 v18, v18
    v_exp_f32 v19, v19
    v_exp_f32 v20, v20
    v_exp_f32 v21, v21
    v_exp_f32 v22, v22
    v_exp_f32 v23, v23
    v_exp_f32 v24, v24
    v_exp_f32 v25, v25
    v_exp_f32 v26, v26
    v_smfmac_f32_32x32x32_bf16 v[44:59], v[176:179], v[12:19], v1
    v_exp_f32 v27, v27
    v_exp_f32 v28, v28
    v_exp_f32 v29, v29
    v_smfmac_f32_32x32x32_bf16 v[44:59], v[180:183], v[20:27], v1
    v_exp_f32 v30, v30
    v_exp_f32 v31, v31
    v_exp_f32 v32, v32
    v_mfma_f32_32x32x16_bf16 v[12:27], v[96:99], v[60:63], 0
    v_exp_f32 v33, v33
    v_exp_f32 v34, v34
    v_exp_f32 v35, v35
    v_exp_f32 v36, v36
    v_exp_f32 v37, v37
    v_exp_f32 v38, v38
    v_exp_f32 v39, v39
    v_exp_f32 v40, v40
    v_exp_f32 v41, v41
    v_exp_f32 v42, v42
    v_smfmac_f32_32x32x32_bf16 v[44:59], v[184:187], v[28:35], v1
    v_exp_f32 v43, v43
    v_exp_f32 v12, v12
    v_exp_f32 v13, v13
    v_smfmac_f32_32x32x32_bf16 v[44:59], v[188:191], v[36:43], v1
    v_exp_f32 v14, v14
    v_exp_f32 v15, v15
    v_exp_f32 v16, v16
    v_mfma_f32_32x32x16_bf16 v[28:43], v[100:103], v[60:63], 0
    v_exp_f32 v17, v17
    v_exp_f32 v18, v18
    v_exp_f32 v19, v19
    v_exp_f32 v20, v20
    v_exp_f32 v21, v21
    v_exp_f32 v22, v22
    v_exp_f32 v23, v23
    v_exp_f32 v24, v24
    v_exp_f32 v25, v25
    v_exp_f32 v26, v26
    v_smfmac_f32_32x32x32_bf16 v[44:59], v[192:195], v[12:19], v1
    v_exp_f32 v27, v27
    v_exp_f32 v28, v28
    v_exp_f32 v29, v29
    v_smfmac_f32_32x32x32_bf16 v[44:59], v[196:199], v[20:27], v1
    v_exp_f32 v30, v30
    v_exp_f32 v31, v31
    v_exp_f32 v32, v32
    v_mfma_f32_32x32x16_bf16 v[12:27], v[104:107], v[60:63], 0
    v_exp_f32 v33, v33
    v_exp_f32 v34, v34
    v_exp_f32 v35, v35
    v_exp_f32 v36, v36
    v_exp_f32 v37, v37
    v_exp_f32 v38, v38
    v_exp_f32 v39, v39
    v_exp_f32 v40, v40
    v_exp_f32 v41, v41
    v_exp_f32 v42, v42
    v_smfmac_f32_32x32x32_bf16 v[44:59], v[200:203], v[28:35], v1
    v_exp_f32 v43, v43
    v_exp_f32 v12, v12
    v_exp_f32 v13, v13
    v_smfmac_f32_32x32x32_bf16 v[44:59], v[204:207], v[36:43], v1
    v_exp_f32 v14, v14
    v_exp_f32 v15, v15
    v_exp_f32 v16, v16
    v_mfma_f32_32x32x16_bf16 v[28:43], v[108:111], v[60:63], 0
    v_exp_f32 v17, v17
    v_exp_f32 v18, v18
    v_exp_f32 v19, v19
    v_exp_f32 v20, v20
    v_exp_f32 v21, v21
    v_exp_f32 v22, v22
    v_exp_f32 v23, v23
    v_exp_f32 v24, v24
    v_exp_f32 v25, v25
    v_exp_f32 v26, v26
    v_smfmac_f32_32x32x32_bf16 v[44:59], v[208:211], v[12:19], v1
    v_exp_f32 v27, v27
    v_exp_f32 v28, v28
    v_exp_f32 v29, v29
    v_smfmac_f32_32x32x32_bf16 v[44:59], v[212:215], v[20:27], v1
    v_exp_f32 v30, v30
    v_exp_f32 v31, v31
    v_exp_f32 v32, v32
    v_mfma_f32_32x32x16_bf16 v[12:27], v[112:115], v[60:63], 0
    v_exp_f32 v33, v33
    v_exp_f32 v34, v34
    v_exp_f32 v35, v35
    v_exp_f32 v36, v36
    v_exp_f32 v37, v37
    v_exp_f32 v38, v38
    v_exp_f32 v39, v39
    v_exp_f32 v40, v40
    v_exp_f32 v41, v41
    v_exp_f32 v42, v42
    v_smfmac_f32_32x32x32_bf16 v[44:59], v[216:219], v[28:35], v1
    v_exp_f32 v43, v43
    v_exp_f32 v12, v12
    v_exp_f32 v13, v13
    v_smfmac_f32_32x32x32_bf16 v[44:59], v[220:223], v[36:43], v1
    v_exp_f32 v14, v14
    v_exp_f32 v15, v15
    v_exp_f32 v16, v16
    v_mfma_f32_32x32x16_bf16 v[28:43], v[116:119], v[60:63], 0
    v_exp_f32 v17, v17
    v_exp_f32 v18, v18
    v_exp_f32 v19, v19
    v_exp_f32 v20, v20
    v_exp_f32 v21, v21
    v_exp_f32 v22, v22
    v_exp_f32 v23, v23
    v_exp_f32 v24, v24
    v_exp_f32 v25, v25
    v_exp_f32 v26, v26
    v_smfmac_f32_32x32x32_bf16 v[44:59], v[224:227], v[12:19], v1
    v_exp_f32 v27, v27
    v_exp_f32 v28, v28
    v_exp_f32 v29, v29
    v_smfmac_f32_32x32x32_bf16 v[44:59], v[228:231], v[20:27], v1
    v_exp_f32 v30, v30
    v_exp_f32 v31, v31
    v_exp_f32 v32, v32
    v_mfma_f32_32x32x16_bf16 v[12:27], v[120:123], v[60:63], 0
    v_exp_f32 v33, v33
    v_exp_f32 v34, v34
    v_exp_f32 v35, v35
    v_exp_f32 v36, v36
    v_exp_f32 v37, v37
    v_exp_f32 v38, v38
    v_exp_f32 v39, v39
    v_exp_f32 v40, v40
    v_exp_f32 v41, v41
    v_exp_f32 v42, v42
    v_smfmac_f32_32x32x32_bf16 v[44:59], v[232:235], v[28:35], v1
    v_exp_f32 v43, v43
    v_exp_f32 v12, v12
    v_exp_f32 v13, v13
    v_smfmac_f32_32x32x32_bf16 v[44:59], v[236:239], v[36:43], v1
    v_exp_f32 v14, v14
    v_exp_f32 v15, v15
    v_exp_f32 v16, v16
    v_mfma_f32_32x32x16_bf16 v[28:43], v[124:127], v[60:63], 0
    ds_read_b32 v8, v7 offset:28
    v_exp_f32 v17, v17
    v_exp_f32 v18, v18
    v_exp_f32 v19, v19
    v_exp_f32 v20, v20
    v_exp_f32 v21, v21
    v_exp_f32 v22, v22
    v_exp_f32 v23, v23
    v_exp_f32 v24, v24
    v_exp_f32 v25, v25
    v_exp_f32 v26, v26
    v_smfmac_f32_32x32x32_bf16 v[44:59], v[240:243], v[12:19], v1
    v_exp_f32 v27, v27
    v_exp_f32 v28, v28
    v_exp_f32 v29, v29
    v_smfmac_f32_32x32x32_bf16 v[44:59], v[244:247], v[20:27], v1
    v_exp_f32 v30, v30
    v_exp_f32 v31, v31
    v_exp_f32 v32, v32
    s_waitcnt lgkmcnt(0)
    v_exp_f32 v33, v33
    v_exp_f32 v34, v34
    v_exp_f32 v35, v35
    v_exp_f32 v36, v36
    v_exp_f32 v37, v37
    v_exp_f32 v38, v38
    v_exp_f32 v39, v39
    v_exp_f32 v40, v40
    v_exp_f32 v41, v41
    v_exp_f32 v42, v42
    v_smfmac_f32_32x32x32_bf16 v[44:59], v[248:251], v[28:35], v1
    v_exp_f32 v43, v43
    s_nop 1
    v_smfmac_f32_32x32x32_bf16 v[44:59], v[252:255], v[36:43], v1
    v_lshlrev_b32 v251, 2, v0
    v_add_u32 v13, 161280, v251
    ds_read_b64 v[18:19], v9 offset:88
    ds_read_b32 v233, v13
    v_and_b32 v14, 3, v0
    v_lshlrev_b32 v14, 8, v14
    v_add_u32 v14, 159744, v14
    v_and_b32 v15, 124, v251
    v_add_u32 v15, 159744, v15
    v_add_u32 v140, s93, v10
    v_cmp_eq_u32 vcc, 0, v8
    s_cbranch_vccnz Lcw_25
Lcwd_26:
    ds_write_b128 v5, v[44:47] offset:24576
    ds_write_b128 v5, v[48:51] offset:25600
    ds_write_b32 v6, v52 offset:3072
    s_setprio 3
    s_mov_b32 s85, s94
    s_waitcnt lgkmcnt(3)
    v_cmp_gt_u32 vcc, 4, v18
    s_cbranch_vccnz Lob_27
Lobd_28:
    v_readfirstlane_b32 s91, v19
    s_lshl_b32 s91, s91, 6
    v_lshl_add_u32 v16, s72, 2, v10
Lfw_29:
    ds_read_b32 v3, v14 offset:208
    s_waitcnt lgkmcnt(0)
    v_cmp_eq_u32 vcc, 0, v3
    s_cbranch_vccz Lfwd_30
    s_cmp_eq_u32 s77, 0
    s_cbranch_scc1 Lfwd_30
    s_sub_u32 s77, s77, 1
    s_branch Lfw_29
Lfwd_30:
    ds_read2st64_b32 v[20:21], v15 offset0:0 offset1:1
    ds_read2st64_b32 v[22:23], v15 offset0:2 offset1:3
    ds_read_b64 v[24:25], v140 offset:0
    ds_read_b64 v[26:27], v140 offset:2048
    ds_read_b64 v[28:29], v140 offset:4096
    ds_read_b64 v[30:31], v140 offset:6144
    s_waitcnt lgkmcnt(4)
    v_add_f32 v20, v20, v22
    v_add_f32 v21, v21, v23
    v_add_f32 v20, v20, v21
    v_rcp_f32 v21, v20
    s_waitcnt lgkmcnt(0)
    v_add_f32 v24, v24, v26
    v_add_f32 v28, v28, v30
    v_add_f32 v25, v25, v27
    v_add_f32 v29, v29, v31
    v_mul_f32 v21, v21, v233
    v_add_f32 v24, v24, v28
    v_add_f32 v25, v25, v29
    v_fma_f32 v20, v24, 0, v20
    v_fma_f32 v20, v25, 0, v20
    v_mul_f32 v24, v24, v21
    v_mul_f32 v25, v25, v21
    v_subrev_u32 v20, 0x2b800000, v20
    v_cmp_lt_u32 vcc, 0x3c000000, v20
    v_cvt_pk_bf16_f32 v24, v24, v25
    s_cbranch_vccnz L_aw_fb
    v_min_u32 v24, -2, v24
    s_cmp_ge_u32 s87, s91
    s_cbranch_scc0 L_aw_far
    buffer_store_dword v24, v16, s[56:59], s85 offen
L_aw_end:
    s_endpgm
Lcw_21:
    s_cmp_eq_u32 s77, 0
    s_cbranch_scc1 Lcwd_22
    s_sub_u32 s77, s77, 1
    s_sleep 1
    ds_read_b32 v8, v7 offset:20
    s_waitcnt lgkmcnt(0)
    v_cmp_eq_u32 vcc, 0, v8
    s_cbranch_vccnz Lcw_21
    s_branch Lcwd_22
Lcw_23:
    s_cmp_eq_u32 s77, 0
    s_cbranch_scc1 Lcwd_24
    s_sub_u32 s77, s77, 1
    s_sleep 1
    ds_read_b32 v8, v7 offset:24
    s_waitcnt lgkmcnt(0)
    v_cmp_eq_u32 vcc, 0, v8
    s_cbranch_vccnz Lcw_23
    s_branch Lcwd_24
Lcw_25:
    s_cmp_eq_u32 s77, 0
    s_cbranch_scc1 Lcwd_26
    s_sub_u32 s77, s77, 1
    s_sleep 1
    ds_read_b32 v8, v7 offset:28
    s_waitcnt lgkmcnt(0)
    v_cmp_eq_u32 vcc, 0, v8
    s_cbranch_vccnz Lcw_25
    s_branch Lcwd_26
L_aw_far:
    buffer_store_dword v24, v16, s[56:59], s85 offen sc1
    s_endpgm
L_aw_fb:
    s_call_b64 s[88:89], L_fb
    s_endpgm
Lob_27:
    s_cmp_eq_u32 s77, 0
    s_cbranch_scc1 Lobd_28
    s_sub_u32 s77, s77, 1
    s_sleep 2
    ds_read_b64 v[18:19], v9 offset:88
    ds_read_b32 v233, v13
    s_waitcnt lgkmcnt(0)
    v_cmp_gt_u32 vcc, 4, v18
    s_cbranch_vccnz Lob_27
    s_branch Lobd_28
.p2align 6
L_sw:
    s_lshl_b32 s75, s73, 3
    s_add_u32 s75, s75, s74
    s_mov_b32 s77, 400000
    s_lshl_b32 s92, s75, 7
    s_add_u32 s92, s92, 524288
    s_setprio 2
    s_and_b32 s78, s72, 3
    s_lshr_b32 s79, s78, 1
    s_and_b32 s80, s78, 1
    v_lshrrev_b32 v11, 3, v0
    v_and_b32 v12, 7, v0
    v_lshrrev_b32 v13, 2, v0
    v_and_b32 v13, 4, v13
    v_xor_b32 v12, v12, v13
    v_lshlrev_b32 v12, 4, v12
    v_lshl_add_u32 v9, v11, 10, v12
    v_mul_u32_u24 v8, 3072, v11
    v_add_u32 v8, v8, v12
    v_and_b32 v11, 31, v0
    s_lshl_b32 s81, s79, 5
    v_add_u32 v13, s81, v11
    v_mul_u32_u24 v4, 1040, v13
    v_lshrrev_b32 v12, 5, v0
    v_lshl_add_u32 v4, v12, 4, v4
    v_and_b32 v13, 15, v0
    v_lshrrev_b32 v16, 2, v13
    v_lshlrev_b32 v14, 7, v16
    v_lshrrev_b32 v15, 3, v13
    v_xor_b32 v15, s80, v15
    v_lshl_add_u32 v14, v15, 6, v14
    v_bfe_u32 v17, v0, 4, 1
    v_lshl_add_u32 v14, v17, 5, v14
    v_and_b32 v18, 3, v0
    v_lshl_add_u32 v14, v18, 3, v14
    v_lshl_add_u32 v5, v12, 10, v14
    v_lshl_add_u32 v7, v12, 9, v14
    v_add_u32 v252, 91136, v5
    v_add_u32 v6, 107520, v7
    v_mov_b32 v1, 1
    v_mov_b32 v250, 0
    v_mov_b32 v2, 160832
    v_lshlrev_b32 v251, 2, v0
    v_min_u32 v15, 16, v11
    v_mad_u32_u24 v234, v12, 20, v15
    v_lshlrev_b32 v234, 4, v234
    v_mul_u32_u24 v15, 10240, v12
    v_lshl_add_u32 v253, v11, 4, v15
    v_lshl_add_u32 v255, v12, 7, v251
    s_lshl_b32 s81, s73, 10
    v_and_b32 v235, 7, v0
    v_lshlrev_b32 v235, 7, v235
    v_add_u32 v235, s81, v235
    s_lshl_b32 s81, s74, 7
    v_lshlrev_b32 v254, 10, v11
    v_add_u32 v254, s81, v254
    v_bfe_u32 v14, v0, 1, 3
    v_xor_b32 v14, v14, v12
    v_lshlrev_b32 v14, 3, v14
    v_lshl_add_u32 v14, v11, 6, v14
    s_lshl_b32 s81, s79, 11
    s_lshl_b32 s82, s80, 13
    s_add_u32 s81, s81, s82
    s_add_u32 s81, s81, 123904
    v_add_u32 v236, s81, v14
    v_xor_b32 v237, 16, v236
    v_xor_b32 v238, 32, v236
    v_xor_b32 v239, 48, v236
    v_lshl_add_u32 v15, v12, 2, v16
    v_lshrrev_b32 v14, 1, v15
    v_lshl_add_u32 v19, v17, 2, v18
    v_xor_b32 v14, v14, v19
    v_lshlrev_b32 v14, 3, v14
    v_lshl_add_u32 v15, v15, 6, v14
    s_lshl_b32 s84, s80, 1
    s_add_u32 s84, s84, s79
    s_lshl_b32 s81, s84, 12
    s_add_u32 s81, s81, 123904
    v_add_u32 v240, s81, v15
    v_xor_b32 v241, 32, v240
    s_lshl_b32 s81, s78, 11
    s_add_u32 s81, s81, 140288
    v_add_u32 v242, s81, v10
    v_lshlrev_b32 v14, 4, v13
    v_lshl_add_u32 v14, v12, 9, v14
    s_lshl_b32 s81, s80, 11
    s_lshl_b32 s82, s79, 8
    s_add_u32 s81, s81, s82
    s_add_u32 s81, s81, 140288
    v_add_u32 v243, s81, v14
    v_lshrrev_b32 v14, 1, v18
    v_lshl_add_u32 v14, v17, 1, v14
    v_lshlrev_b32 v14, 3, v14
    v_lshl_add_u32 v244, v16, 5, v14
    v_lshl_add_u32 v244, v12, 7, v244
    s_lshl_b32 s81, s80, 10
    s_add_u32 s81, s81, 161792
    v_add_u32 v244, s81, v244
    v_lshlrev_b32 v245, 31, v16
    v_or_b32 v245, 0x3fb8aa3b, v245
    s_lshl_b32 s81, s78, 11
    s_add_u32 s81, s81, 66560
    v_add_u32 v246, s81, v10
    s_lshl_b32 s93, s78, 12
    s_waitcnt lgkmcnt(0)
    s_mov_b32 s56, s28
    s_mov_b32 s57, s29
    s_mov_b32 s58, 0x800000
    s_mov_b32 s59, 0x20000
    s_mov_b32 s44, s16
    s_mov_b32 s45, s17
    s_mov_b32 s46, 0x180000
    s_mov_b32 s47, 0x20000
    s_mov_b32 s48, s12
    s_mov_b32 s49, s13
    s_mov_b32 s50, 0x80000
    s_mov_b32 s51, 0x20000
    s_mov_b32 s52, s20
    s_mov_b32 s53, s21
    s_mov_b32 s54, 0x80000
    s_mov_b32 s55, 0x20000
    s_mov_b32 s60, s24
    s_mov_b32 s61, s25
    s_mov_b32 s62, 0x200000
    s_mov_b32 s63, 0x20000
    s_lshl_b32 s82, s74, 7
    s_mul_i32 s94, s80, 98304
    s_add_u32 s94, s94, s82
    s_lshl_b32 s82, s79, 10
    s_add_u32 s94, s94, s82
    s_add_u32 s94, s94, 1024
    s_lshr_b32 s81, s2, 2
    s_mul_i32 s81, s81, 3072
    s_and_b32 s82, s2, 3
    s_lshl_b32 s82, s82, 2
    s_add_u32 s82, s82, s78
    s_lshl_b32 s82, s82, 7
    s_add_u32 s81, s81, s82
    s_add_u32 s81, s81, 1024
    s_add_u32 s68, s16, s81
    s_addc_u32 s69, s17, 0
    s_add_u32 s70, s68, 786432
    s_addc_u32 s71, s69, 0
    s_barrier
    s_barrier
    ds_read_b64_tr_b16 v[16:17], v244 offset:0
    ds_read_b64_tr_b16 v[18:19], v244 offset:256
    ds_read_b64_tr_b16 v[20:21], v244 offset:512
    ds_read_b64_tr_b16 v[22:23], v244 offset:768
    ds_read_b128 v[104:107], v4 offset:0
    ds_read_b128 v[108:111], v4 offset:32
    ds_read_b128 v[112:115], v4 offset:64
    ds_read_b128 v[116:119], v4 offset:96
    ds_read_b128 v[120:123], v4 offset:128
    ds_read_b128 v[124:127], v4 offset:160
    ds_read_b128 v[128:131], v4 offset:192
    ds_read_b128 v[132:135], v4 offset:224
    s_waitcnt lgkmcnt(8)
    v_lshlrev_b32 v14, 16, v16
    v_and_b32 v15, 0xffff0000, v16
    ds_read_b128 v[136:139], v4 offset:256
    v_mul_f32 v14, v14, v245
    v_mul_f32 v15, v15, v245
    ds_read_b128 v[140:143], v4 offset:288
    v_cvt_pk_bf16_f32 v16, v14, v15
    ds_read_b128 v[144:147], v4 offset:320
    v_lshlrev_b32 v14, 16, v17
    v_and_b32 v15, 0xffff0000, v17
    ds_read_b128 v[148:151], v4 offset:352
    v_mul_f32 v14, v14, v245
    v_mul_f32 v15, v15, v245
    ds_read_b128 v[152:155], v4 offset:384
    v_cvt_pk_bf16_f32 v17, v14, v15
    ds_read_b128 v[156:159], v4 offset:416
    v_lshlrev_b32 v14, 16, v18
    v_and_b32 v15, 0xffff0000, v18
    ds_read_b128 v[160:163], v4 offset:448
    v_mul_f32 v14, v14, v245
    v_mul_f32 v15, v15, v245
    ds_read_b128 v[164:167], v4 offset:480
    v_cvt_pk_bf16_f32 v18, v14, v15
    ds_read_b128 v[168:171], v4 offset:512
    v_lshlrev_b32 v14, 16, v19
    v_and_b32 v15, 0xffff0000, v19
    ds_read_b128 v[172:175], v4 offset:544
    v_mul_f32 v14, v14, v245
    v_mul_f32 v15, v15, v245
    ds_read_b128 v[176:179], v4 offset:576
    v_cvt_pk_bf16_f32 v19, v14, v15
    ds_read_b128 v[180:183], v4 offset:608
    v_lshlrev_b32 v14, 16, v20
    v_and_b32 v15, 0xffff0000, v20
    ds_read_b128 v[184:187], v4 offset:640
    v_mul_f32 v14, v14, v245
    v_mul_f32 v15, v15, v245
    ds_read_b128 v[188:191], v4 offset:672
    v_cvt_pk_bf16_f32 v20, v14, v15
    ds_read_b128 v[192:195], v4 offset:704
    v_lshlrev_b32 v14, 16, v21
    v_and_b32 v15, 0xffff0000, v21
    ds_read_b128 v[196:199], v4 offset:736
    v_mul_f32 v14, v14, v245
    v_mul_f32 v15, v15, v245
    ds_read_b128 v[200:203], v4 offset:768
    v_cvt_pk_bf16_f32 v21, v14, v15
    ds_read_b128 v[204:207], v4 offset:800
    v_lshlrev_b32 v14, 16, v22
    v_and_b32 v15, 0xffff0000, v22
    ds_read_b128 v[208:211], v4 offset:832
    v_mul_f32 v14, v14, v245
    v_mul_f32 v15, v15, v245
    ds_read_b128 v[212:215], v4 offset:864
    v_cvt_pk_bf16_f32 v22, v14, v15
    ds_read_b128 v[216:219], v4 offset:896
    v_lshlrev_b32 v14, 16, v23
    v_and_b32 v15, 0xffff0000, v23
    ds_read_b128 v[220:223], v4 offset:928
    v_mul_f32 v14, v14, v245
    v_mul_f32 v15, v15, v245
    ds_read_b128 v[224:227], v4 offset:960
    v_cvt_pk_bf16_f32 v23, v14, v15
    ds_read_b128 v[228:231], v4 offset:992
    ds_read_b32 v3, v2 offset:8
    s_waitcnt lgkmcnt(0)
Lsbr_32:
    v_readfirstlane_b32 s81, v3
    s_cmp_ge_u32 s81, 2
    s_cbranch_scc1 Lsbd_31
    s_cmp_eq_u32 s77, 0
    s_cbranch_scc1 Lsbd_31
    s_sub_u32 s77, s77, 1
    ds_read_b32 v3, v2 offset:8
    s_waitcnt lgkmcnt(0)
    s_branch Lsbr_32
Lsbd_31:
    ds_read_b64_tr_b16 v[72:73], v252 offset:16384
    ds_read_b64_tr_b16 v[74:75], v252 offset:16896
    ds_read_b64_tr_b16 v[76:77], v252 offset:18432
    ds_read_b64_tr_b16 v[78:79], v252 offset:18944
    ds_read_b64_tr_b16 v[80:81], v252 offset:20480
    ds_read_b64_tr_b16 v[82:83], v252 offset:20992
    ds_read_b64_tr_b16 v[84:85], v252 offset:22528
    ds_read_b64_tr_b16 v[86:87], v252 offset:23040
    s_waitcnt lgkmcnt(6)
    v_mfma_f32_32x32x16_bf16 v[40:55], v[72:75], v[104:107], 0
    ds_read_b64_tr_b16 v[88:89], v252 offset:24576
    ds_read_b64_tr_b16 v[90:91], v252 offset:25088
    s_waitcnt lgkmcnt(6)
    v_mfma_f32_32x32x16_bf16 v[40:55], v[76:79], v[108:111], v[40:55]
    ds_read_b64_tr_b16 v[92:93], v252 offset:26624
    ds_read_b64_tr_b16 v[94:95], v252 offset:27136
    ds_read_b32 v3, v2 offset:12
    s_waitcnt lgkmcnt(7)
    v_mfma_f32_32x32x16_bf16 v[40:55], v[80:83], v[112:115], v[40:55]
    ds_read_b64_tr_b16 v[96:97], v252 offset:28672
    ds_read_b64_tr_b16 v[98:99], v252 offset:29184
    s_waitcnt lgkmcnt(7)
    v_mfma_f32_32x32x16_bf16 v[40:55], v[84:87], v[116:119], v[40:55]
    ds_read_b64_tr_b16 v[100:101], v252 offset:30720
    ds_read_b64_tr_b16 v[102:103], v252 offset:31232
    s_waitcnt lgkmcnt(4)
    v_readfirstlane_b32 s81, v3
    v_mfma_f32_32x32x16_bf16 v[40:55], v[88:91], v[120:123], v[40:55]
    s_cmp_lt_u32 s81, 2
    s_cbranch_scc1 Lqr_33
Lqd_34:
    ds_read_b64_tr_b16 v[72:73], v252 offset:32768
    ds_read_b64_tr_b16 v[74:75], v252 offset:33280
    v_mfma_f32_32x32x16_bf16 v[40:55], v[92:95], v[124:127], v[40:55]
    ds_read_b64_tr_b16 v[76:77], v252 offset:34816
    ds_read_b64_tr_b16 v[78:79], v252 offset:35328
    s_waitcnt lgkmcnt(6)
    v_mfma_f32_32x32x16_bf16 v[40:55], v[96:99], v[128:131], v[40:55]
    ds_read_b64_tr_b16 v[80:81], v252 offset:36864
    ds_read_b64_tr_b16 v[82:83], v252 offset:37376
    s_waitcnt lgkmcnt(6)
    v_mfma_f32_32x32x16_bf16 v[40:55], v[100:103], v[132:135], v[40:55]
    ds_read_b64_tr_b16 v[84:85], v252 offset:38912
    ds_read_b64_tr_b16 v[86:87], v252 offset:39424
    s_waitcnt lgkmcnt(6)
    v_mfma_f32_32x32x16_bf16 v[40:55], v[72:75], v[136:139], v[40:55]
    ds_read_b64_tr_b16 v[88:89], v252 offset:40960
    ds_read_b64_tr_b16 v[90:91], v252 offset:41472
    s_waitcnt lgkmcnt(6)
    v_mfma_f32_32x32x16_bf16 v[40:55], v[76:79], v[140:143], v[40:55]
    ds_read_b64_tr_b16 v[92:93], v252 offset:43008
    ds_read_b64_tr_b16 v[94:95], v252 offset:43520
    ds_read_b32 v3, v2 offset:16
    s_waitcnt lgkmcnt(7)
    v_mfma_f32_32x32x16_bf16 v[40:55], v[80:83], v[144:147], v[40:55]
    ds_read_b64_tr_b16 v[96:97], v252 offset:45056
    ds_read_b64_tr_b16 v[98:99], v252 offset:45568
    s_waitcnt lgkmcnt(7)
    v_mfma_f32_32x32x16_bf16 v[40:55], v[84:87], v[148:151], v[40:55]
    ds_read_b64_tr_b16 v[100:101], v252 offset:47104
    ds_read_b64_tr_b16 v[102:103], v252 offset:47616
    s_waitcnt lgkmcnt(4)
    v_readfirstlane_b32 s81, v3
    v_mfma_f32_32x32x16_bf16 v[40:55], v[88:91], v[152:155], v[40:55]
    s_cmp_lt_u32 s81, 2
    s_cbranch_scc1 Lqr_35
Lqd_36:
    ds_read_b64_tr_b16 v[72:73], v252 offset:49152
    ds_read_b64_tr_b16 v[74:75], v252 offset:49664
    v_mfma_f32_32x32x16_bf16 v[40:55], v[92:95], v[156:159], v[40:55]
    ds_read_b64_tr_b16 v[76:77], v252 offset:51200
    ds_read_b64_tr_b16 v[78:79], v252 offset:51712
    s_waitcnt lgkmcnt(6)
    v_mfma_f32_32x32x16_bf16 v[40:55], v[96:99], v[160:163], v[40:55]
    ds_read_b64_tr_b16 v[80:81], v252 offset:53248
    ds_read_b64_tr_b16 v[82:83], v252 offset:53760
    s_waitcnt lgkmcnt(6)
    v_mfma_f32_32x32x16_bf16 v[40:55], v[100:103], v[164:167], v[40:55]
    ds_read_b64_tr_b16 v[84:85], v252 offset:55296
    ds_read_b64_tr_b16 v[86:87], v252 offset:55808
    s_waitcnt lgkmcnt(6)
    v_mfma_f32_32x32x16_bf16 v[40:55], v[72:75], v[168:171], v[40:55]
    ds_read_b64_tr_b16 v[88:89], v252 offset:57344
    ds_read_b64_tr_b16 v[90:91], v252 offset:57856
    s_waitcnt lgkmcnt(6)
    v_mfma_f32_32x32x16_bf16 v[40:55], v[76:79], v[172:175], v[40:55]
    ds_read_b64_tr_b16 v[92:93], v252 offset:59392
    ds_read_b64_tr_b16 v[94:95], v252 offset:59904
    ds_read_b32 v3, v2 offset:20
    s_waitcnt lgkmcnt(7)
    v_mfma_f32_32x32x16_bf16 v[40:55], v[80:83], v[176:179], v[40:55]
    ds_read_b64_tr_b16 v[96:97], v252 offset:61440
    ds_read_b64_tr_b16 v[98:99], v252 offset:61952
    s_waitcnt lgkmcnt(7)
    v_mfma_f32_32x32x16_bf16 v[40:55], v[84:87], v[180:183], v[40:55]
    ds_read_b64_tr_b16 v[100:101], v252 offset:63488
    ds_read_b64_tr_b16 v[102:103], v252 offset:64000
    s_waitcnt lgkmcnt(4)
    v_readfirstlane_b32 s81, v3
    v_mfma_f32_32x32x16_bf16 v[40:55], v[88:91], v[184:187], v[40:55]
    s_cmp_lt_u32 s81, 2
    s_cbranch_scc1 Lqr_37
Lqd_38:
    ds_read_b64_tr_b16 v[72:73], v252 offset:0
    ds_read_b64_tr_b16 v[74:75], v252 offset:512
    v_mfma_f32_32x32x16_bf16 v[40:55], v[92:95], v[188:191], v[40:55]
    ds_read_b64_tr_b16 v[76:77], v252 offset:2048
    ds_read_b64_tr_b16 v[78:79], v252 offset:2560
    s_waitcnt lgkmcnt(6)
    v_mfma_f32_32x32x16_bf16 v[40:55], v[96:99], v[192:195], v[40:55]
    ds_read_b64_tr_b16 v[80:81], v252 offset:4096
    ds_read_b64_tr_b16 v[82:83], v252 offset:4608
    s_waitcnt lgkmcnt(6)
    v_mfma_f32_32x32x16_bf16 v[40:55], v[100:103], v[196:199], v[40:55]
    ds_read_b64_tr_b16 v[84:85], v252 offset:6144
    ds_read_b64_tr_b16 v[86:87], v252 offset:6656
    s_waitcnt lgkmcnt(6)
    v_mfma_f32_32x32x16_bf16 v[40:55], v[72:75], v[200:203], v[40:55]
    ds_read_b64_tr_b16 v[88:89], v252 offset:8192
    ds_read_b64_tr_b16 v[90:91], v252 offset:8704
    s_waitcnt lgkmcnt(6)
    v_mfma_f32_32x32x16_bf16 v[40:55], v[76:79], v[204:207], v[40:55]
    ds_read_b64_tr_b16 v[92:93], v252 offset:10240
    ds_read_b64_tr_b16 v[94:95], v252 offset:10752
    s_waitcnt lgkmcnt(6)
    v_mfma_f32_32x32x16_bf16 v[40:55], v[80:83], v[208:211], v[40:55]
    ds_read_b64_tr_b16 v[96:97], v252 offset:12288
    ds_read_b64_tr_b16 v[98:99], v252 offset:12800
    s_waitcnt lgkmcnt(6)
    v_mfma_f32_32x32x16_bf16 v[40:55], v[84:87], v[212:215], v[40:55]
    ds_read_b64_tr_b16 v[100:101], v252 offset:14336
    ds_read_b64_tr_b16 v[102:103], v252 offset:14848
    s_waitcnt lgkmcnt(6)
    v_mfma_f32_32x32x16_bf16 v[40:55], v[88:91], v[216:219], v[40:55]
    s_waitcnt lgkmcnt(4)
    v_mfma_f32_32x32x16_bf16 v[40:55], v[92:95], v[220:223], v[40:55]
    s_waitcnt lgkmcnt(2)
    v_mfma_f32_32x32x16_bf16 v[40:55], v[96:99], v[224:227], v[40:55]
    s_waitcnt lgkmcnt(0)
    v_mfma_f32_32x32x16_bf16 v[40:55], v[100:103], v[228:231], v[40:55]
    s_mov_b32 s82, 0x3eb8aa3b
    s_mov_b32 s83, 0x3eb8aa3b
    s_nop 9
    v_pk_mul_f32 v[40:41], v[40:41], s[82:83]
    v_pk_mul_f32 v[42:43], v[42:43], s[82:83]
    v_pk_mul_f32 v[44:45], v[44:45], s[82:83]
    v_pk_mul_f32 v[46:47], v[46:47], s[82:83]
    v_cvt_pk_bf16_f32 v24, v40, v41
    v_cvt_pk_bf16_f32 v25, v42, v43
    v_cvt_pk_bf16_f32 v26, v44, v45
    v_cvt_pk_bf16_f32 v27, v46, v47
    ds_write_b128 v246, v[24:27] offset:0
    v_pk_mul_f32 v[48:49], v[48:49], s[82:83]
    v_pk_mul_f32 v[50:51], v[50:51], s[82:83]
    v_pk_mul_f32 v[52:53], v[52:53], s[82:83]
    v_pk_mul_f32 v[54:55], v[54:55], s[82:83]
    v_cvt_pk_bf16_f32 v28, v48, v49
    v_cvt_pk_bf16_f32 v29, v50, v51
    v_cvt_pk_bf16_f32 v30, v52, v53
    v_cvt_pk_bf16_f32 v31, v54, v55
    ds_write_b128 v246, v[28:31] offset:1024
    s_mov_b64 exec, 1
    ds_add_u32 v2, v1 offset:4
    s_mov_b64 exec, -1
    s_branch L_sw_q
Lqr_33:
    s_cmp_eq_u32 s77, 0
    s_cbranch_scc1 Lqd_34
    s_sub_u32 s77, s77, 1
    ds_read_b32 v3, v2 offset:12
    s_waitcnt lgkmcnt(0)
    v_readfirstlane_b32 s81, v3
    s_cmp_lt_u32 s81, 2
    s_cbranch_scc1 Lqr_33
    s_branch Lqd_34
Lqr_35:
    s_cmp_eq_u32 s77, 0
    s_cbranch_scc1 Lqd_36
    s_sub_u32 s77, s77, 1
    ds_read_b32 v3, v2 offset:16
    s_waitcnt lgkmcnt(0)
    v_readfirstlane_b32 s81, v3
    s_cmp_lt_u32 s81, 2
    s_cbranch_scc1 Lqr_35
    s_branch Lqd_36
Lqr_37:
    s_cmp_eq_u32 s77, 0
    s_cbranch_scc1 Lqd_38
    s_sub_u32 s77, s77, 1
    ds_read_b32 v3, v2 offset:20
    s_waitcnt lgkmcnt(0)
    v_readfirstlane_b32 s81, v3
    s_cmp_lt_u32 s81, 2
    s_cbranch_scc1 Lqr_37
    s_branch Lqd_38
L_sw_q:
    v_mov_b32 v244, -1
    v_mov_b32 v245, -1
    v_mov_b32 v246, -1
    v_mov_b32 v247, -1
    s_load_dword s96, s[68:69], 0
    s_load_dword s96, s[68:69], 64
    s_load_dword s96, s[68:69], 196608
    s_load_dword s96, s[68:69], 196672
    s_load_dword s96, s[68:69], 393216
    s_load_dword s96, s[68:69], 393280
    s_load_dword s96, s[68:69], 589824
    s_load_dword s96, s[68:69], 589888
    s_load_dword s96, s[70:71], 0
    s_load_dword s96, s[70:71], 64
    s_load_dword s96, s[70:71], 196608
    s_load_dword s96, s[70:71], 196672
    s_load_dword s96, s[70:71], 393216
    s_load_dword s96, s[70:71], 393280
    s_load_dword s96, s[70:71], 589824
    s_load_dword s96, s[70:71], 589888
    v_and_b32 v13, 124, v251
    s_lshl_b32 s83, s73, 9
    s_add_u32 s83, s83, 196608
    s_lshl_b32 s82, s79, 7
    s_add_u32 s83, s83, s82
    s_xor_b32 s84, s83, 128
    v_and_b32 v15, 7, v0
    v_lshlrev_b32 v15, 3, v15
    s_lshl_b32 s85, s73, 7
    s_add_u32 s85, s85, 524288
    s_getreg_b32 s90, hwreg(HW_REG_XCC_ID)
    ds_read_b32 v3, v2 offset:0
    s_waitcnt lgkmcnt(0)
    v_readfirstlane_b32 s81, v3
    s_cmp_lt_u32 s81, 4
    s_cbranch_scc1 Lsbr_40
Lsbd_39:
    s_add_u32 m0, s93, 0
    s_add_u32 s82, s94, 0
    buffer_load_dwordx4 v8, s[44:47], s82 offen lds
    s_add_u32 m0, s93, 1024
    s_add_u32 s82, s94, 24576
    buffer_load_dwordx4 v8, s[44:47], s82 offen lds
    s_add_u32 m0, s93, 2048
    s_add_u32 s82, s94, 49152
    buffer_load_dwordx4 v8, s[44:47], s82 offen lds
    s_add_u32 m0, s93, 3072
    s_add_u32 s82, s94, 73728
    buffer_load_dwordx4 v8, s[44:47], s82 offen lds
    v_mov_b32 v14, 160768
    ds_read_b32 v232, v14
    buffer_load_dword v11, v13, s[56:59], s83 offen sc1
    buffer_load_dword v12, v13, s[56:59], s84 offen sc1
    buffer_load_dword v249, v15, s[56:59], s85 offen offset:4 sc1
    s_add_u32 m0, s93, 16384
    s_add_u32 s82, s94, 196608
    buffer_load_dwordx4 v8, s[44:47], s82 offen lds
    s_add_u32 m0, s93, 17408
    s_add_u32 s82, s94, 221184
    buffer_load_dwordx4 v8, s[44:47], s82 offen lds
    s_add_u32 m0, s93, 18432
    s_add_u32 s82, s94, 245760
    buffer_load_dwordx4 v8, s[44:47], s82 offen lds
    s_add_u32 m0, s93, 19456
    s_add_u32 s82, s94, 270336
    buffer_load_dwordx4 v8, s[44:47], s82 offen lds
    s_add_u32 m0, s93, 32768
    s_add_u32 s82, s94, 393216
    buffer_load_dwordx4 v8, s[44:47], s82 offen lds
    s_add_u32 m0, s93, 33792
    s_add_u32 s82, s94, 417792
    buffer_load_dwordx4 v8, s[44:47], s82 offen lds
    s_add_u32 m0, s93, 34816
    s_add_u32 s82, s94, 442368
    buffer_load_dwordx4 v8, s[44:47], s82 offen lds
    s_add_u32 m0, s93, 35840
    s_add_u32 s82, s94, 466944
    buffer_load_dwordx4 v8, s[44:47], s82 offen lds
    v_lshlrev_b32 v13, 7, v0
    s_waitcnt vmcnt(11)
    s_mov_b64 exec, 1
    ds_add_u32 v2, v1 offset:36
    s_mov_b64 exec, -1
    s_waitcnt vmcnt(8)
    v_max_u32 v3, v11, v12
    v_cmp_eq_u32 vcc, -1, v3
    s_cbranch_vccnz Lgl_41
Lgld_42:
    ds_read_b32 v3, v2 offset:36
    s_waitcnt lgkmcnt(0)
    v_readfirstlane_b32 s81, v3
    s_cmp_lt_u32 s81, 4
    s_cbranch_scc1 Lsbr_44
Lsbd_43:
    v_readfirstlane_b32 s76, v232
    v_cmp_ne_u32 vcc, s90, v249
    s_cmp_eq_u64 vcc, 0
    s_cselect_b32 s91, 0, 64
    s_cbranch_scc1 Lnear_45
    s_mov_b64 exec, 1
    ds_add_u32 v2, v1 offset:28
    s_mov_b64 exec, -1
Lnear_45:
    s_lshl_b32 s95, s73, 2
    s_add_u32 s95, s95, s78
    s_lshl_b32 s95, s95, 15
    s_lshl_b32 s82, s74, 12
    s_add_u32 s95, s95, s82
    s_add_u32 s95, s95, 4194304
    ds_read_b64_tr_b16 v[72:73], v5 offset:0
    ds_read_b64_tr_b16 v[74:75], v5 offset:512
    ds_read_b64_tr_b16 v[76:77], v5 offset:8192
    ds_read_b64_tr_b16 v[78:79], v5 offset:8704
    ds_read_b64_tr_b16 v[80:81], v5 offset:2048
    ds_read_b64_tr_b16 v[82:83], v5 offset:2560
    ds_read_b64_tr_b16 v[84:85], v5 offset:10240
    ds_read_b64_tr_b16 v[86:87], v5 offset:10752
    ds_read_b64_tr_b16 v[88:89], v5 offset:4096
    ds_read_b64_tr_b16 v[90:91], v5 offset:4608
    ds_read_b64_tr_b16 v[92:93], v5 offset:12288
    ds_read_b64_tr_b16 v[94:95], v5 offset:12800
    s_setprio 0
    s_waitcnt lgkmcnt(8)
    v_mfma_f32_32x32x16_bf16 v[40:55], v[72:75], v[104:107], 0
    v_mfma_f32_32x32x16_bf16 v[56:71], v[104:107], v[76:79], 0
    s_waitcnt vmcnt(4)
    s_mov_b64 exec, 1
    ds_add_u32 v2, v1 offset:40
    s_mov_b64 exec, -1
    ds_read_b32 v3, v2 offset:40
    ds_read_b64_tr_b16 v[96:97], v5 offset:6144
    ds_read_b64_tr_b16 v[98:99], v5 offset:6656
    ds_read_b64_tr_b16 v[100:101], v5 offset:14336
    ds_read_b64_tr_b16 v[102:103], v5 offset:14848
    s_add_u32 m0, s93, 49152
    s_add_u32 s82, s94, 589824
    buffer_load_dwordx4 v8, s[44:47], s82 offen lds
    s_add_u32 m0, s93, 50176
    s_add_u32 s82, s94, 614400
    buffer_load_dwordx4 v8, s[44:47], s82 offen lds
    s_waitcnt lgkmcnt(10)
    v_mfma_f32_32x32x16_bf16 v[40:55], v[80:83], v[108:111], v[40:55]
    v_mfma_f32_32x32x16_bf16 v[56:71], v[108:111], v[84:87], v[56:71]
    s_setprio 2
    s_waitcnt lgkmcnt(4)
    v_readfirstlane_b32 s81, v3
    s_cmp_lt_u32 s81, 4
    s_cbranch_scc1 Lsbr_47
Lsbd_46:
    s_setprio 0
    ds_read_b64_tr_b16 v[24:25], v5 offset:16384
    ds_read_b64_tr_b16 v[26:27], v5 offset:16896
    ds_read_b64_tr_b16 v[28:29], v5 offset:24576
    ds_read_b64_tr_b16 v[30:31], v5 offset:25088
    s_add_u32 m0, s93, 51200
    s_add_u32 s82, s94, 638976
    buffer_load_dwordx4 v8, s[44:47], s82 offen lds
    s_add_u32 m0, s93, 52224
    s_add_u32 s82, s94, 663552
    buffer_load_dwordx4 v8, s[44:47], s82 offen lds
    v_mfma_f32_32x32x16_bf16 v[40:55], v[88:91], v[112:115], v[40:55]
    v_mfma_f32_32x32x16_bf16 v[56:71], v[112:115], v[92:95], v[56:71]
    ds_read_b64_tr_b16 v[32:33], v5 offset:18432
    ds_read_b64_tr_b16 v[34:35], v5 offset:18944
    ds_read_b64_tr_b16 v[36:37], v5 offset:26624
    ds_read_b64_tr_b16 v[38:39], v5 offset:27136
    s_add_u32 m0, s93, 107520
    s_add_u32 s82, s94, 786432
    buffer_load_dwordx4 v8, s[44:47], s82 offen lds
    s_add_u32 m0, s93, 108544
    s_add_u32 s82, s94, 811008
    buffer_load_dwordx4 v8, s[44:47], s82 offen lds
    s_waitcnt lgkmcnt(8)
    v_mfma_f32_32x32x16_bf16 v[40:55], v[96:99], v[116:119], v[40:55]
    v_mfma_f32_32x32x16_bf16 v[56:71], v[116:119], v[100:103], v[56:71]
    s_waitcnt vmcnt(2)
    s_mov_b64 exec, 1
    ds_add_u32 v2, v1 offset:44
    s_mov_b64 exec, -1
    ds_read_b64_tr_b16 v[72:73], v5 offset:20480
    ds_read_b64_tr_b16 v[74:75], v5 offset:20992
    ds_read_b64_tr_b16 v[76:77], v5 offset:28672
    ds_read_b64_tr_b16 v[78:79], v5 offset:29184
    s_add_u32 m0, s93, 109568
    s_add_u32 s82, s94, 835584
    buffer_load_dwordx4 v8, s[44:47], s82 offen lds
    s_add_u32 m0, s93, 110592
    s_add_u32 s82, s94, 860160
    buffer_load_dwordx4 v8, s[44:47], s82 offen lds
    s_waitcnt lgkmcnt(9)
    v_mfma_f32_32x32x16_bf16 v[40:55], v[24:27], v[120:123], v[40:55]
    v_mfma_f32_32x32x16_bf16 v[56:71], v[120:123], v[28:31], v[56:71]
    ds_read_b32 v3, v2 offset:44
    ds_read_b64_tr_b16 v[80:81], v5 offset:22528
    ds_read_b64_tr_b16 v[82:83], v5 offset:23040
    ds_read_b64_tr_b16 v[84:85], v5 offset:30720
    ds_read_b64_tr_b16 v[86:87], v5 offset:31232
    s_add_u32 m0, s93, 123904
    s_add_u32 s82, s94, 983040
    buffer_load_dwordx4 v8, s[44:47], s82 offen lds
    s_add_u32 m0, s93, 124928
    s_add_u32 s82, s94, 1007616
    buffer_load_dwordx4 v8, s[44:47], s82 offen lds
    s_waitcnt lgkmcnt(10)
    v_mfma_f32_32x32x16_bf16 v[40:55], v[32:35], v[124:127], v[40:55]
    v_mfma_f32_32x32x16_bf16 v[56:71], v[124:127], v[36:39], v[56:71]
    s_setprio 2
    s_waitcnt lgkmcnt(4)
    v_readfirstlane_b32 s81, v3
    s_cmp_lt_u32 s81, 4
    s_cbranch_scc1 Lsbr_49
Lsbd_48:
    s_setprio 0
    ds_read_b64_tr_b16 v[88:89], v5 offset:32768
    ds_read_b64_tr_b16 v[90:91], v5 offset:33280
    ds_read_b64_tr_b16 v[92:93], v5 offset:40960
    ds_read_b64_tr_b16 v[94:95], v5 offset:41472
    s_add_u32 m0, s93, 125952
    s_add_u32 s82, s94, 1032192
    buffer_load_dwordx4 v8, s[44:47], s82 offen lds
    s_add_u32 m0, s93, 126976
    s_add_u32 s82, s94, 1056768
    buffer_load_dwordx4 v8, s[44:47], s82 offen lds
    v_mfma_f32_32x32x16_bf16 v[40:55], v[72:75], v[128:131], v[40:55]
    v_mfma_f32_32x32x16_bf16 v[56:71], v[128:131], v[76:79], v[56:71]
    ds_read_b64_tr_b16 v[96:97], v5 offset:34816
    ds_read_b64_tr_b16 v[98:99], v5 offset:35328
    ds_read_b64_tr_b16 v[100:101], v5 offset:43008
    ds_read_b64_tr_b16 v[102:103], v5 offset:43520
    s_add_u32 m0, s93, 140288
    s_add_u32 s82, s94, 1179648
    buffer_load_dwordx4 v8, s[44:47], s82 offen lds
    s_add_u32 m0, s93, 141312
    s_add_u32 s82, s94, 1204224
    buffer_load_dwordx4 v8, s[44:47], s82 offen lds
    s_waitcnt lgkmcnt(8)
    v_mfma_f32_32x32x16_bf16 v[40:55], v[80:83], v[132:135], v[40:55]
    v_mfma_f32_32x32x16_bf16 v[56:71], v[132:135], v[84:87], v[56:71]
    ds_read_b64_tr_b16 v[24:25], v5 offset:36864
    ds_read_b64_tr_b16 v[26:27], v5 offset:37376
    ds_read_b64_tr_b16 v[28:29], v5 offset:45056
    ds_read_b64_tr_b16 v[30:31], v5 offset:45568
    s_add_u32 m0, s93, 142336
    s_add_u32 s82, s94, 1228800
    buffer_load_dwordx4 v8, s[44:47], s82 offen lds
    s_add_u32 m0, s93, 143360
    s_add_u32 s82, s94, 1253376
    buffer_load_dwordx4 v8, s[44:47], s82 offen lds
    s_waitcnt lgkmcnt(8)
    v_mfma_f32_32x32x16_bf16 v[40:55], v[88:91], v[136:139], v[40:55]
    v_mfma_f32_32x32x16_bf16 v[56:71], v[136:139], v[92:95], v[56:71]
    ds_read_b64_tr_b16 v[32:33], v5 offset:38912
    ds_read_b64_tr_b16 v[34:35], v5 offset:39424
    ds_read_b64_tr_b16 v[36:37], v5 offset:47104
    ds_read_b64_tr_b16 v[38:39], v5 offset:47616
    s_add_u32 m0, s93, 0
    s_add_u32 s82, s94, 1376256
    buffer_load_dwordx4 v8, s[44:47], s82 offen lds
    s_add_u32 m0, s93, 1024
    s_add_u32 s82, s94, 1400832
    buffer_load_dwordx4 v8, s[44:47], s82 offen lds
    s_waitcnt lgkmcnt(8)
    v_mfma_f32_32x32x16_bf16 v[40:55], v[96:99], v[140:143], v[40:55]
    v_mfma_f32_32x32x16_bf16 v[56:71], v[140:143], v[100:103], v[56:71]
    ds_read_b64_tr_b16 v[72:73], v5 offset:49152
    ds_read_b64_tr_b16 v[74:75], v5 offset:49664
    ds_read_b64_tr_b16 v[76:77], v5 offset:57344
    ds_read_b64_tr_b16 v[78:79], v5 offset:57856
    s_add_u32 m0, s93, 2048
    s_add_u32 s82, s94, 1425408
    buffer_load_dwordx4 v8, s[44:47], s82 offen lds
    s_add_u32 m0, s93, 3072
    s_add_u32 s82, s94, 1449984
    buffer_load_dwordx4 v8, s[44:47], s82 offen lds
    s_waitcnt lgkmcnt(8)
    v_mfma_f32_32x32x16_bf16 v[40:55], v[24:27], v[144:147], v[40:55]
    v_mfma_f32_32x32x16_bf16 v[56:71], v[144:147], v[28:31], v[56:71]
    ds_read_b64_tr_b16 v[80:81], v5 offset:51200
    ds_read_b64_tr_b16 v[82:83], v5 offset:51712
    ds_read_b64_tr_b16 v[84:85], v5 offset:59392
    ds_read_b64_tr_b16 v[86:87], v5 offset:59904
    s_waitcnt lgkmcnt(8)
    v_mfma_f32_32x32x16_bf16 v[40:55], v[32:35], v[148:151], v[40:55]
    v_mfma_f32_32x32x16_bf16 v[56:71], v[148:151], v[36:39], v[56:71]
    s_waitcnt vmcnt(8)
    s_mov_b64 exec, 1
    ds_add_u32 v2, v1 offset:48
    s_mov_b64 exec, -1
    ds_read_b64_tr_b16 v[88:89], v5 offset:53248
    ds_read_b64_tr_b16 v[90:91], v5 offset:53760
    ds_read_b64_tr_b16 v[92:93], v5 offset:61440
    ds_read_b64_tr_b16 v[94:95], v5 offset:61952
    s_waitcnt lgkmcnt(9)
    v_mfma_f32_32x32x16_bf16 v[40:55], v[72:75], v[152:155], v[40:55]
    v_mfma_f32_32x32x16_bf16 v[56:71], v[152:155], v[76:79], v[56:71]
    ds_read_b32 v3, v2 offset:48
    ds_read_b64_tr_b16 v[96:97], v5 offset:55296
    ds_read_b64_tr_b16 v[98:99], v5 offset:55808
    ds_read_b64_tr_b16 v[100:101], v5 offset:63488
    ds_read_b64_tr_b16 v[102:103], v5 offset:64000
    s_waitcnt lgkmcnt(10)
    v_mfma_f32_32x32x16_bf16 v[40:55], v[80:83], v[156:159], v[40:55]
    v_mfma_f32_32x32x16_bf16 v[56:71], v[156:159], v[84:87], v[56:71]
    s_setprio 2
    s_waitcnt lgkmcnt(4)
    v_readfirstlane_b32 s81, v3
    s_cmp_lt_u32 s81, 4
    s_cbranch_scc1 Lsbr_51
Lsbd_50:
    s_setprio 0
    ds_read_b64_tr_b16 v[24:25], v252 offset:16384
    ds_read_b64_tr_b16 v[26:27], v252 offset:16896
    ds_read_b64_tr_b16 v[28:29], v252 offset:24576
    ds_read_b64_tr_b16 v[30:31], v252 offset:25088
    s_lshl_b32 s82, s74, 7
    s_mul_i32 s94, s78, 98304
    s_add_u32 s94, s94, s82
    s_add_u32 m0, s93, 16384
    s_add_u32 s82, s94, 0
    buffer_load_dwordx4 v8, s[44:47], s82 offen lds
    s_add_u32 m0, s93, 17408
    s_add_u32 s82, s94, 24576
    buffer_load_dwordx4 v8, s[44:47], s82 offen lds
    v_mfma_f32_32x32x16_bf16 v[40:55], v[88:91], v[160:163], v[40:55]
    v_mfma_f32_32x32x16_bf16 v[56:71], v[160:163], v[92:95], v[56:71]
    ds_read_b64_tr_b16 v[32:33], v252 offset:18432
    ds_read_b64_tr_b16 v[34:35], v252 offset:18944
    ds_read_b64_tr_b16 v[36:37], v252 offset:26624
    ds_read_b64_tr_b16 v[38:39], v252 offset:27136
    s_add_u32 m0, s93, 18432
    s_add_u32 s82, s94, 49152
    buffer_load_dwordx4 v8, s[44:47], s82 offen lds
    s_add_u32 m0, s93, 19456
    s_add_u32 s82, s94, 73728
    buffer_load_dwordx4 v8, s[44:47], s82 offen lds
    s_waitcnt lgkmcnt(8)
    v_mfma_f32_32x32x16_bf16 v[40:55], v[96:99], v[164:167], v[40:55]
    v_mfma_f32_32x32x16_bf16 v[56:71], v[164:167], v[100:103], v[56:71]
    ds_read_b64_tr_b16 v[72:73], v252 offset:20480
    ds_read_b64_tr_b16 v[74:75], v252 offset:20992
    ds_read_b64_tr_b16 v[76:77], v252 offset:28672
    ds_read_b64_tr_b16 v[78:79], v252 offset:29184
    s_add_u32 m0, s93, 32768
    s_add_u32 s82, s94, 393216
    buffer_load_dwordx4 v8, s[44:47], s82 offen lds
    s_lshl_b32 s81, s2, 2
    s_add_u32 s81, s81, s78
    s_lshl_b32 s81, s81, 9
    s_mov_b64 exec, 15
    buffer_load_dword v249, v13, s[48:51], s81 offen
    buffer_load_dword v249, v13, s[52:55], s81 offen
    s_lshr_b32 s82, s81, 10
    s_lshl_b32 s82, s82, 11
    s_add_u32 s81, s81, s82
    buffer_load_dword v249, v13, s[44:47], s81 offen
    s_mov_b64 exec, -1
    s_add_u32 m0, s93, 33792
    s_add_u32 s82, s94, 417792
    buffer_load_dwordx4 v8, s[44:47], s82 offen lds
    s_waitcnt lgkmcnt(8)
    v_mfma_f32_32x32x16_bf16 v[40:55], v[24:27], v[168:171], v[40:55]
    v_mfma_f32_32x32x16_bf16 v[56:71], v[168:171], v[28:31], v[56:71]
    ds_read_b64_tr_b16 v[80:81], v252 offset:22528
    ds_read_b64_tr_b16 v[82:83], v252 offset:23040
    ds_read_b64_tr_b16 v[84:85], v252 offset:30720
    ds_read_b64_tr_b16 v[86:87], v252 offset:31232
    s_add_u32 m0, s93, 34816
    s_add_u32 s82, s94, 442368
    buffer_load_dwordx4 v8, s[44:47], s82 offen lds
    s_add_u32 m0, s93, 35840
    s_add_u32 s82, s94, 466944
    buffer_load_dwordx4 v8, s[44:47], s82 offen lds
    s_waitcnt lgkmcnt(8)
    v_mfma_f32_32x32x16_bf16 v[40:55], v[32:35], v[172:175], v[40:55]
    v_mfma_f32_32x32x16_bf16 v[56:71], v[172:175], v[36:39], v[56:71]
    ds_read_b64_tr_b16 v[88:89], v252 offset:32768
    ds_read_b64_tr_b16 v[90:91], v252 offset:33280
    ds_read_b64_tr_b16 v[92:93], v252 offset:40960
    ds_read_b64_tr_b16 v[94:95], v252 offset:41472
    s_waitcnt lgkmcnt(8)
    v_mfma_f32_32x32x16_bf16 v[40:55], v[72:75], v[176:179], v[40:55]
    v_mfma_f32_32x32x16_bf16 v[56:71], v[176:179], v[76:79], v[56:71]
    ds_read_b64_tr_b16 v[96:97], v252 offset:34816
    ds_read_b64_tr_b16 v[98:99], v252 offset:35328
    ds_read_b64_tr_b16 v[100:101], v252 offset:43008
    ds_read_b64_tr_b16 v[102:103], v252 offset:43520
    s_waitcnt lgkmcnt(8)
    v_mfma_f32_32x32x16_bf16 v[40:55], v[80:83], v[180:183], v[40:55]
    v_mfma_f32_32x32x16_bf16 v[56:71], v[180:183], v[84:87], v[56:71]
    s_waitcnt vmcnt(11)
    s_mov_b64 exec, 1
    ds_add_u32 v2, v1 offset:52
    s_mov_b64 exec, -1
    ds_read_b64_tr_b16 v[24:25], v252 offset:36864
    ds_read_b64_tr_b16 v[26:27], v252 offset:37376
    ds_read_b64_tr_b16 v[28:29], v252 offset:45056
    ds_read_b64_tr_b16 v[30:31], v252 offset:45568
    s_waitcnt lgkmcnt(9)
    v_mfma_f32_32x32x16_bf16 v[40:55], v[88:91], v[184:187], v[40:55]
    v_mfma_f32_32x32x16_bf16 v[56:71], v[184:187], v[92:95], v[56:71]
    ds_read_b32 v3, v2 offset:52
    ds_read_b64_tr_b16 v[32:33], v252 offset:38912
    ds_read_b64_tr_b16 v[34:35], v252 offset:39424
    ds_read_b64_tr_b16 v[36:37], v252 offset:47104
    ds_read_b64_tr_b16 v[38:39], v252 offset:47616
    s_waitcnt lgkmcnt(10)
    v_mfma_f32_32x32x16_bf16 v[40:55], v[96:99], v[188:191], v[40:55]
    v_mfma_f32_32x32x16_bf16 v[56:71], v[188:191], v[100:103], v[56:71]
    s_setprio 2
    s_waitcnt lgkmcnt(4)
    v_readfirstlane_b32 s81, v3
    s_cmp_lt_u32 s81, 4
    s_cbranch_scc1 Lsbr_53
Lsbd_52:
    s_setprio 0
    ds_read_b64_tr_b16 v[72:73], v252 offset:49152
    ds_read_b64_tr_b16 v[74:75], v252 offset:49664
    ds_read_b64_tr_b16 v[76:77], v252 offset:57344
    ds_read_b64_tr_b16 v[78:79], v252 offset:57856
    s_add_u32 m0, s93, 49152
    s_add_u32 s82, s94, 786432
    buffer_load_dwordx4 v8, s[44:47], s82 offen lds
    s_add_u32 m0, s93, 50176
    s_add_u32 s82, s94, 811008
    buffer_load_dwordx4 v8, s[44:47], s82 offen lds
    v_mfma_f32_32x32x16_bf16 v[40:55], v[24:27], v[192:195], v[40:55]
    v_mfma_f32_32x32x16_bf16 v[56:71], v[192:195], v[28:31], v[56:71]
    ds_read_b64_tr_b16 v[80:81], v252 offset:51200
    ds_read_b64_tr_b16 v[82:83], v252 offset:51712
    ds_read_b64_tr_b16 v[84:85], v252 offset:59392
    ds_read_b64_tr_b16 v[86:87], v252 offset:59904
    s_add_u32 m0, s93, 51200
    s_add_u32 s82, s94, 835584
    buffer_load_dwordx4 v8, s[44:47], s82 offen lds
    s_add_u32 m0, s93, 52224
    s_add_u32 s82, s94, 860160
    buffer_load_dwordx4 v8, s[44:47], s82 offen lds
    s_waitcnt lgkmcnt(8)
    v_mfma_f32_32x32x16_bf16 v[40:55], v[32:35], v[196:199], v[40:55]
    v_mfma_f32_32x32x16_bf16 v[56:71], v[196:199], v[36:39], v[56:71]
    ds_read_b64_tr_b16 v[88:89], v252 offset:53248
    ds_read_b64_tr_b16 v[90:91], v252 offset:53760
    ds_read_b64_tr_b16 v[92:93], v252 offset:61440
    ds_read_b64_tr_b16 v[94:95], v252 offset:61952
    s_add_u32 m0, s93, 107520
    s_add_u32 s82, s94, 1179648
    buffer_load_dwordx4 v8, s[44:47], s82 offen lds
    s_add_u32 m0, s93, 108544
    s_add_u32 s82, s94, 1204224
    buffer_load_dwordx4 v8, s[44:47], s82 offen lds
    s_waitcnt lgkmcnt(8)
    v_mfma_f32_32x32x16_bf16 v[40:55], v[72:75], v[200:203], v[40:55]
    v_mfma_f32_32x32x16_bf16 v[56:71], v[200:203], v[76:79], v[56:71]
    ds_read_b64_tr_b16 v[96:97], v252 offset:55296
    ds_read_b64_tr_b16 v[98:99], v252 offset:55808
    ds_read_b64_tr_b16 v[100:101], v252 offset:63488
    ds_read_b64_tr_b16 v[102:103], v252 offset:64000
    s_add_u32 m0, s93, 109568
    s_add_u32 s82, s94, 1228800
    buffer_load_dwordx4 v8, s[44:47], s82 offen lds
    s_add_u32 m0, s93, 110592
    s_add_u32 s82, s94, 1253376
    buffer_load_dwordx4 v8, s[44:47], s82 offen lds
    s_waitcnt lgkmcnt(8)
    v_mfma_f32_32x32x16_bf16 v[40:55], v[80:83], v[204:207], v[40:55]
    v_mfma_f32_32x32x16_bf16 v[56:71], v[204:207], v[84:87], v[56:71]
    ds_read_b64_tr_b16 v[24:25], v5 offset:0
    ds_read_b64_tr_b16 v[26:27], v5 offset:512
    ds_read_b64_tr_b16 v[28:29], v5 offset:8192
    ds_read_b64_tr_b16 v[30:31], v5 offset:8704
    s_waitcnt lgkmcnt(8)
    v_mfma_f32_32x32x16_bf16 v[40:55], v[88:91], v[208:211], v[40:55]
    v_mfma_f32_32x32x16_bf16 v[56:71], v[208:211], v[92:95], v[56:71]
    ds_read_b64_tr_b16 v[32:33], v5 offset:2048
    ds_read_b64_tr_b16 v[34:35], v5 offset:2560
    ds_read_b64_tr_b16 v[36:37], v5 offset:10240
    ds_read_b64_tr_b16 v[38:39], v5 offset:10752
    s_waitcnt lgkmcnt(8)
    v_mfma_f32_32x32x16_bf16 v[40:55], v[96:99], v[212:215], v[40:55]
    v_mfma_f32_32x32x16_bf16 v[56:71], v[212:215], v[100:103], v[56:71]
    ds_read_b64_tr_b16 v[72:73], v5 offset:4096
    ds_read_b64_tr_b16 v[74:75], v5 offset:4608
    ds_read_b64_tr_b16 v[76:77], v5 offset:12288
    ds_read_b64_tr_b16 v[78:79], v5 offset:12800
    s_waitcnt lgkmcnt(8)
    v_mfma_f32_32x32x16_bf16 v[40:55], v[24:27], v[216:219], v[40:55]
    v_mfma_f32_32x32x16_bf16 v[56:71], v[216:219], v[28:31], v[56:71]
    ds_read_b64_tr_b16 v[80:81], v5 offset:6144
    ds_read_b64_tr_b16 v[82:83], v5 offset:6656
    ds_read_b64_tr_b16 v[84:85], v5 offset:14336
    ds_read_b64_tr_b16 v[86:87], v5 offset:14848
    s_mov_b64 exec, 1
    ds_add_u32 v2, v1 offset:56
    s_mov_b64 exec, -1
    s_waitcnt lgkmcnt(9)
    v_mfma_f32_32x32x16_bf16 v[40:55], v[32:35], v[220:223], v[40:55]
    v_mfma_f32_32x32x16_bf16 v[56:71], v[220:223], v[36:39], v[56:71]
    s_waitcnt lgkmcnt(5)
    v_mfma_f32_32x32x16_bf16 v[40:55], v[72:75], v[224:227], v[40:55]
    v_mfma_f32_32x32x16_bf16 v[56:71], v[224:227], v[76:79], v[56:71]
    s_waitcnt lgkmcnt(1)
    v_mfma_f32_32x32x16_bf16 v[40:55], v[80:83], v[228:231], v[40:55]
    v_mfma_f32_32x32x16_bf16 v[56:71], v[228:231], v[84:87], v[56:71]
    s_setprio 2
    ds_read_b32 v3, v2 offset:56
    s_lshl_b32 s84, s80, 1
    s_add_u32 s84, s84, s79
    s_lshl_b32 s83, s74, 2
    s_add_u32 s83, s83, s84
    s_lshl_b32 s83, s83, 8
    s_add_u32 s83, s83, s73
    s_mul_i32 s85, s83, 320
    s_add_u32 s85, s85, 1048576
    s_nop 0
    v_cvt_pk_bf16_f32 v24, v40, v41
    v_cvt_pk_bf16_f32 v25, v42, v43
    v_cvt_pk_bf16_f32 v26, v44, v45
    v_cvt_pk_bf16_f32 v27, v46, v47
    v_cvt_pk_bf16_f32 v28, v48, v49
    v_cvt_pk_bf16_f32 v29, v50, v51
    v_cvt_pk_bf16_f32 v30, v52, v53
    v_cvt_pk_bf16_f32 v31, v54, v55
    v_cvt_pk_bf16_f32 v32, v56, v57
    v_cvt_pk_bf16_f32 v33, v58, v59
    v_cvt_pk_bf16_f32 v34, v60, v61
    v_cvt_pk_bf16_f32 v35, v62, v63
    v_cvt_pk_bf16_f32 v36, v64, v65
    v_cvt_pk_bf16_f32 v37, v66, v67
    v_cvt_pk_bf16_f32 v38, v68, v69
    v_cvt_pk_bf16_f32 v39, v70, v71
    s_waitcnt lgkmcnt(0)
    v_readfirstlane_b32 s81, v3
    s_cmp_lt_u32 s81, 4
    s_cbranch_scc1 Lsbr_55
Lsbd_54:
    ds_write_b128 v242, v[32:35]
    ds_write_b128 v242, v[36:39] offset:1024
    s_lshl_b32 s82, s74, 7
    s_lshl_b32 s94, s78, 15
    s_add_u32 s94, s94, s82
    s_add_u32 m0, s93, 0
    s_add_u32 s82, s94, 0
    buffer_load_dwordx4 v9, s[52:55], s82 offen lds
    s_add_u32 m0, s93, 1024
    s_add_u32 s82, s94, 8192
    buffer_load_dwordx4 v9, s[52:55], s82 offen lds
    s_add_u32 m0, s93, 2048
    s_add_u32 s82, s94, 16384
    buffer_load_dwordx4 v9, s[52:55], s82 offen lds
    s_add_u32 m0, s93, 3072
    s_add_u32 s82, s94, 24576
    buffer_load_dwordx4 v9, s[52:55], s82 offen lds
    s_setprio 0
    v_mfma_f32_32x32x16_bf16 v[72:87], v[16:19], v[24:27], 0
    v_mfma_f32_32x32x16_bf16 v[40:55], v[20:23], v[28:31], 0
    s_setprio 2
    s_nop 9
    v_exp_f32 v72, v72
    v_exp_f32 v73, v73
    v_exp_f32 v74, v74
    v_exp_f32 v75, v75
    v_exp_f32 v76, v76
    v_exp_f32 v77, v77
    v_exp_f32 v78, v78
    v_exp_f32 v79, v79
    v_exp_f32 v80, v80
    v_exp_f32 v81, v81
    v_exp_f32 v82, v82
    v_exp_f32 v83, v83
    v_exp_f32 v84, v84
    v_exp_f32 v85, v85
    v_exp_f32 v86, v86
    v_exp_f32 v87, v87
    v_pk_add_f32 v[88:89], v[72:73], v[74:75]
    v_pk_add_f32 v[90:91], v[76:77], v[78:79]
    v_pk_add_f32 v[88:89], v[88:89], v[80:81]
    v_pk_add_f32 v[90:91], v[90:91], v[82:83]
    v_pk_add_f32 v[88:89], v[88:89], v[84:85]
    v_pk_add_f32 v[90:91], v[90:91], v[86:87]
    v_pk_add_f32 v[88:89], v[88:89], v[90:91]
    v_add_f32 v88, v88, v89
    v_subrev_u32 v89, 0x2b800000, v88
    v_cmp_lt_u32 vcc, 0x3c000000, v89
    s_cbranch_vccnz Lff_56
Lffb_57:
    v_rcp_f32 v88, v88
    s_nop 0
    v_pk_mul_f32 v[72:73], v[72:73], v[88:89] op_sel_hi:[1,0]
    v_pk_mul_f32 v[74:75], v[74:75], v[88:89] op_sel_hi:[1,0]
    v_pk_mul_f32 v[76:77], v[76:77], v[88:89] op_sel_hi:[1,0]
    v_pk_mul_f32 v[78:79], v[78:79], v[88:89] op_sel_hi:[1,0]
    v_pk_mul_f32 v[80:81], v[80:81], v[88:89] op_sel_hi:[1,0]
    v_pk_mul_f32 v[82:83], v[82:83], v[88:89] op_sel_hi:[1,0]
    v_pk_mul_f32 v[84:85], v[84:85], v[88:89] op_sel_hi:[1,0]
    v_pk_mul_f32 v[86:87], v[86:87], v[88:89] op_sel_hi:[1,0]
    v_cvt_pk_bf16_f32 v96, v72, v73
    v_cvt_pk_bf16_f32 v97, v74, v75
    v_cvt_pk_bf16_f32 v98, v76, v77
    v_cvt_pk_bf16_f32 v99, v78, v79
    v_cvt_pk_bf16_f32 v100, v80, v81
    v_cvt_pk_bf16_f32 v101, v82, v83
    v_cvt_pk_bf16_f32 v102, v84, v85
    v_cvt_pk_bf16_f32 v103, v86, v87
    ds_write_b64 v236, v[96:97] offset:0
    ds_write_b64 v237, v[98:99] offset:0
    ds_write_b64 v238, v[100:101] offset:0
    ds_write_b64 v239, v[102:103] offset:0
    v_exp_f32 v40, v40
    v_exp_f32 v41, v41
    v_exp_f32 v42, v42
    v_exp_f32 v43, v43
    v_exp_f32 v44, v44
    v_exp_f32 v45, v45
    v_exp_f32 v46, v46
    v_exp_f32 v47, v47
    v_exp_f32 v48, v48
    v_exp_f32 v49, v49
    v_exp_f32 v50, v50
    v_exp_f32 v51, v51
    v_exp_f32 v52, v52
    v_exp_f32 v53, v53
    v_exp_f32 v54, v54
    v_exp_f32 v55, v55
    v_pk_add_f32 v[88:89], v[40:41], v[42:43]
    v_pk_add_f32 v[90:91], v[44:45], v[46:47]
    v_pk_add_f32 v[88:89], v[88:89], v[48:49]
    v_pk_add_f32 v[90:91], v[90:91], v[50:51]
    v_pk_add_f32 v[88:89], v[88:89], v[52:53]
    v_pk_add_f32 v[90:91], v[90:91], v[54:55]
    v_pk_add_f32 v[88:89], v[88:89], v[90:91]
    v_add_f32 v88, v88, v89
    v_subrev_u32 v89, 0x2b800000, v88
    v_cmp_lt_u32 vcc, 0x3c000000, v89
    s_cbranch_vccnz Lff_58
Lffb_59:
    v_rcp_f32 v88, v88
    s_nop 0
    v_pk_mul_f32 v[40:41], v[40:41], v[88:89] op_sel_hi:[1,0]
    v_pk_mul_f32 v[42:43], v[42:43], v[88:89] op_sel_hi:[1,0]
    v_pk_mul_f32 v[44:45], v[44:45], v[88:89] op_sel_hi:[1,0]
    v_pk_mul_f32 v[46:47], v[46:47], v[88:89] op_sel_hi:[1,0]
    v_pk_mul_f32 v[48:49], v[48:49], v[88:89] op_sel_hi:[1,0]
    v_pk_mul_f32 v[50:51], v[50:51], v[88:89] op_sel_hi:[1,0]
    v_pk_mul_f32 v[52:53], v[52:53], v[88:89] op_sel_hi:[1,0]
    v_pk_mul_f32 v[54:55], v[54:55], v[88:89] op_sel_hi:[1,0]
    v_cvt_pk_bf16_f32 v96, v40, v41
    v_cvt_pk_bf16_f32 v97, v42, v43
    v_cvt_pk_bf16_f32 v98, v44, v45
    v_cvt_pk_bf16_f32 v99, v46, v47
    v_cvt_pk_bf16_f32 v100, v48, v49
    v_cvt_pk_bf16_f32 v101, v50, v51
    v_cvt_pk_bf16_f32 v102, v52, v53
    v_cvt_pk_bf16_f32 v103, v54, v55
    ds_write_b64 v236, v[96:97] offset:4096
    ds_write_b64 v237, v[98:99] offset:4096
    ds_write_b64 v238, v[100:101] offset:4096
    ds_write_b64 v239, v[102:103] offset:4096
    s_waitcnt vmcnt(0)
    s_mov_b64 exec, 1
    ds_add_u32 v2, v1 offset:60
    s_mov_b64 exec, -1
    s_mov_b32 s82, 0x3f803f80
    s_mov_b32 s83, 0x3f803f80
    v_mov_b64 v[56:57], s[82:83]
    v_mov_b64 v[58:59], s[82:83]
    v_mov_b64 v[60:61], s[82:83]
    v_mov_b64 v[62:63], s[82:83]
    v_mov_b64 v[64:65], s[82:83]
    v_mov_b64 v[66:67], s[82:83]
    v_mov_b64 v[68:69], s[82:83]
    v_mov_b64 v[70:71], s[82:83]
    ds_read_b32 v3, v2 offset:60
    s_waitcnt lgkmcnt(0)
    v_readfirstlane_b32 s81, v3
    s_cmp_lt_u32 s81, 4
    s_cbranch_scc1 Lsbr_61
Lsbd_60:
    ds_read_b64_tr_b16 v[72:73], v240 offset:0
    ds_read_b64_tr_b16 v[74:75], v241 offset:512
    ds_read_b64_tr_b16 v[76:77], v240 offset:1024
    ds_read_b64_tr_b16 v[78:79], v241 offset:1536
    ds_read_b64_tr_b16 v[80:81], v240 offset:2048
    ds_read_b64_tr_b16 v[82:83], v241 offset:2560
    ds_read_b64_tr_b16 v[84:85], v240 offset:3072
    ds_read_b64_tr_b16 v[86:87], v241 offset:3584
    s_mov_b32 exec_lo, 0xffff
    s_mov_b32 exec_hi, 0xffff
    ds_read_b128 v[56:59], v243 offset:0
    ds_read_b128 v[60:63], v243 offset:1024
    ds_read_b128 v[64:67], v243 offset:4096
    ds_read_b128 v[68:71], v243 offset:5120
    s_mov_b64 exec, -1
    s_waitcnt lgkmcnt(0)
    s_setprio 0
    v_mfma_f32_32x32x16_bf16 v[40:55], v[72:75], v[56:59], 0
    v_mfma_f32_32x32x16_bf16 v[40:55], v[76:79], v[60:63], v[40:55]
    v_mfma_f32_32x32x16_bf16 v[40:55], v[80:83], v[64:67], v[40:55]
    v_mfma_f32_32x32x16_bf16 v[40:55], v[84:87], v[68:71], v[40:55]
    s_setprio 2
    buffer_store_dwordx4 v[244:247], v10, s[56:59], s95 offen offset:0 sc1
    buffer_store_dwordx4 v[244:247], v10, s[56:59], s95 offen offset:1024 sc1
    buffer_store_dwordx4 v[244:247], v10, s[56:59], s95 offen offset:2048 sc1
    buffer_store_dwordx4 v[244:247], v10, s[56:59], s95 offen offset:3072 sc1
    s_cmp_lg_u32 s78, 2
    s_cbranch_scc1 Lonly_62
    s_and_b32 s81, s73, 3
    s_lshl_b32 s82, s74, 2
    s_add_u32 s81, s81, s82
    s_lshl_b32 s81, s81, 2
    s_lshr_b32 s82, s73, 3
    s_add_u32 s81, s81, s82
    s_lshl_b32 s81, s81, 9
    s_and_b32 s82, s73, 4
    s_lshl_b32 s82, s82, 5
    s_add_u32 s81, s81, s82
    s_add_u32 s81, s81, 131072
    buffer_store_dword v244, v255, s[56:59], s81 offen sc1
Lonly_62:
    s_mov_b32 exec_lo, 0xfffff
    s_mov_b32 exec_hi, 0xfffff
    s_nop 2
    buffer_store_dwordx4 v[40:43], v253, s[56:59], s85 offen sc1
    s_add_u32 s85, s85, 20480
    buffer_store_dwordx4 v[44:47], v253, s[56:59], s85 offen sc1
    s_add_u32 s85, s85, 20480
    buffer_store_dwordx4 v[48:51], v253, s[56:59], s85 offen sc1
    s_add_u32 s85, s85, 20480
    buffer_store_dwordx4 v[52:55], v253, s[56:59], s85 offen sc1
    s_mov_b64 exec, -1
    ds_read_b64_tr_b16 v[88:89], v5 offset:16384
    ds_read_b64_tr_b16 v[90:91], v5 offset:16896
    ds_read_b64_tr_b16 v[92:93], v5 offset:18432
    ds_read_b64_tr_b16 v[94:95], v5 offset:18944
    ds_read_b64_tr_b16 v[96:97], v5 offset:20480
    ds_read_b64_tr_b16 v[98:99], v5 offset:20992
    ds_read_b64_tr_b16 v[100:101], v5 offset:22528
    ds_read_b64_tr_b16 v[102:103], v5 offset:23040
    ds_read_b64_tr_b16 v[24:25], v5 offset:24576
    ds_read_b64_tr_b16 v[26:27], v5 offset:25088
    ds_read_b64_tr_b16 v[28:29], v5 offset:26624
    ds_read_b64_tr_b16 v[30:31], v5 offset:27136
    s_setprio 0
    s_waitcnt lgkmcnt(8)
    v_mfma_f32_32x32x16_bf16 v[56:71], v[88:91], v[104:107], 0
    v_mfma_f32_32x32x16_bf16 v[56:71], v[92:95], v[108:111], v[56:71]
    ds_read_b64_tr_b16 v[32:33], v5 offset:28672
    ds_read_b64_tr_b16 v[34:35], v5 offset:29184
    ds_read_b64_tr_b16 v[36:37], v5 offset:30720
    ds_read_b64_tr_b16 v[38:39], v5 offset:31232
    s_waitcnt lgkmcnt(8)
    v_mfma_f32_32x32x16_bf16 v[56:71], v[96:99], v[112:115], v[56:71]
    v_mfma_f32_32x32x16_bf16 v[56:71], v[100:103], v[116:119], v[56:71]
    ds_read_b64_tr_b16 v[72:73], v5 offset:32768
    ds_read_b64_tr_b16 v[74:75], v5 offset:33280
    ds_read_b64_tr_b16 v[76:77], v5 offset:34816
    ds_read_b64_tr_b16 v[78:79], v5 offset:35328
    s_waitcnt lgkmcnt(8)
    v_mfma_f32_32x32x16_bf16 v[56:71], v[24:27], v[120:123], v[56:71]
    v_mfma_f32_32x32x16_bf16 v[56:71], v[28:31], v[124:127], v[56:71]
    ds_read_b64_tr_b16 v[80:81], v5 offset:36864
    ds_read_b64_tr_b16 v[82:83], v5 offset:37376
    ds_read_b64_tr_b16 v[84:85], v5 offset:38912
    ds_read_b64_tr_b16 v[86:87], v5 offset:39424
    s_waitcnt lgkmcnt(8)
    v_mfma_f32_32x32x16_bf16 v[56:71], v[32:35], v[128:131], v[56:71]
    v_mfma_f32_32x32x16_bf16 v[56:71], v[36:39], v[132:135], v[56:71]
    ds_read_b64_tr_b16 v[88:89], v5 offset:40960
    ds_read_b64_tr_b16 v[90:91], v5 offset:41472
    ds_read_b64_tr_b16 v[92:93], v5 offset:43008
    ds_read_b64_tr_b16 v[94:95], v5 offset:43520
    s_waitcnt lgkmcnt(8)
    v_mfma_f32_32x32x16_bf16 v[56:71], v[72:75], v[136:139], v[56:71]
    v_mfma_f32_32x32x16_bf16 v[56:71], v[76:79], v[140:143], v[56:71]
    ds_read_b64_tr_b16 v[96:97], v5 offset:45056
    ds_read_b64_tr_b16 v[98:99], v5 offset:45568
    ds_read_b64_tr_b16 v[100:101], v5 offset:47104
    ds_read_b64_tr_b16 v[102:103], v5 offset:47616
    s_waitcnt vmcnt(0)
    s_mov_b64 exec, 1
    ds_add_u32 v2, v1 offset:64
    s_mov_b64 exec, -1
    s_waitcnt lgkmcnt(9)
    v_mfma_f32_32x32x16_bf16 v[56:71], v[80:83], v[144:147], v[56:71]
    v_mfma_f32_32x32x16_bf16 v[56:71], v[84:87], v[148:151], v[56:71]
    ds_read_b64_tr_b16 v[24:25], v5 offset:49152
    ds_read_b64_tr_b16 v[26:27], v5 offset:49664
    ds_read_b64_tr_b16 v[28:29], v5 offset:51200
    ds_read_b64_tr_b16 v[30:31], v5 offset:51712
    s_waitcnt lgkmcnt(9)
    v_mfma_f32_32x32x16_bf16 v[56:71], v[88:91], v[152:155], v[56:71]
    v_mfma_f32_32x32x16_bf16 v[56:71], v[92:95], v[156:159], v[56:71]
    ds_read_b64_tr_b16 v[32:33], v5 offset:53248
    ds_read_b64_tr_b16 v[34:35], v5 offset:53760
    ds_read_b64_tr_b16 v[36:37], v5 offset:55296
    ds_read_b64_tr_b16 v[38:39], v5 offset:55808
    ds_read_b32 v3, v2 offset:64
    s_setprio 2
    s_waitcnt lgkmcnt(0)
    v_readfirstlane_b32 s81, v3
    s_cmp_lt_u32 s81, 4
    s_cbranch_scc1 Lsbr_64
Lsbd_63:
    s_setprio 0
    s_cmp_lg_u32 s78, 2
    s_cbranch_scc1 Lonly_65
    s_add_u32 s81, s92, 32768
    s_mov_b32 exec_hi, 0
    buffer_store_dword v232, v251, s[56:59], s81 offen sc1
    s_mov_b32 exec_hi, -1
Lonly_65:
    v_mfma_f32_32x32x16_bf16 v[56:71], v[96:99], v[160:163], v[56:71]
    v_mfma_f32_32x32x16_bf16 v[56:71], v[100:103], v[164:167], v[56:71]
    ds_read_b64_tr_b16 v[72:73], v5 offset:57344
    ds_read_b64_tr_b16 v[74:75], v5 offset:57856
    ds_read_b64_tr_b16 v[76:77], v5 offset:59392
    ds_read_b64_tr_b16 v[78:79], v5 offset:59904
    s_add_u32 m0, s93, 123904
    s_add_u32 s82, s94, 131072
    buffer_load_dwordx4 v9, s[52:55], s82 offen lds
    s_add_u32 m0, s93, 124928
    s_add_u32 s82, s94, 139264
    buffer_load_dwordx4 v9, s[52:55], s82 offen lds
    s_setprio 2
    s_cmp_lg_u32 s79, 0
    s_cbranch_scc1 Lonly_66
    s_mov_b32 s87, s80
    v_mov_b32 v233, v11
    s_call_b64 s[88:89], L_fin
    s_nop 1
Lonly_66:
    s_cmp_lg_u32 s78, 3
    s_cbranch_scc1 Lonly_67
    s_mov_b32 s87, 2
    v_mov_b32 v233, v12
    s_call_b64 s[88:89], L_fin
    s_nop 1
Lonly_67:
    s_setprio 0
    v_mfma_f32_32x32x16_bf16 v[56:71], v[24:27], v[168:171], v[56:71]
    v_mfma_f32_32x32x16_bf16 v[56:71], v[28:31], v[172:175], v[56:71]
    ds_read_b64_tr_b16 v[80:81], v5 offset:61440
    ds_read_b64_tr_b16 v[82:83], v5 offset:61952
    ds_read_b64_tr_b16 v[84:85], v5 offset:63488
    ds_read_b64_tr_b16 v[86:87], v5 offset:64000
    s_add_u32 m0, s93, 125952
    s_add_u32 s82, s94, 147456
    buffer_load_dwordx4 v9, s[52:55], s82 offen lds
    s_add_u32 m0, s93, 126976
    s_add_u32 s82, s94, 155648
    buffer_load_dwordx4 v9, s[52:55], s82 offen lds
    v_mfma_f32_32x32x16_bf16 v[56:71], v[32:35], v[176:179], v[56:71]
    v_mfma_f32_32x32x16_bf16 v[56:71], v[36:39], v[180:183], v[56:71]
    ds_read_b64_tr_b16 v[88:89], v252 offset:16384
    ds_read_b64_tr_b16 v[90:91], v252 offset:16896
    ds_read_b64_tr_b16 v[92:93], v252 offset:18432
    ds_read_b64_tr_b16 v[94:95], v252 offset:18944
    s_add_u32 m0, s93, 140288
    s_add_u32 s82, s94, 262144
    buffer_load_dwordx4 v9, s[52:55], s82 offen lds
    s_add_u32 m0, s93, 141312
    s_add_u32 s82, s94, 270336
    buffer_load_dwordx4 v9, s[52:55], s82 offen lds
    s_waitcnt lgkmcnt(8)
    v_mfma_f32_32x32x16_bf16 v[56:71], v[72:75], v[184:187], v[56:71]
    v_mfma_f32_32x32x16_bf16 v[56:71], v[76:79], v[188:191], v[56:71]
    ds_read_b64_tr_b16 v[96:97], v252 offset:20480
    ds_read_b64_tr_b16 v[98:99], v252 offset:20992
    ds_read_b64_tr_b16 v[100:101], v252 offset:22528
    ds_read_b64_tr_b16 v[102:103], v252 offset:23040
    s_add_u32 m0, s93, 142336
    s_add_u32 s82, s94, 278528
    buffer_load_dwordx4 v9, s[52:55], s82 offen lds
    s_add_u32 m0, s93, 143360
    s_add_u32 s82, s94, 286720
    buffer_load_dwordx4 v9, s[52:55], s82 offen lds
    s_waitcnt lgkmcnt(8)
    v_mfma_f32_32x32x16_bf16 v[56:71], v[80:83], v[192:195], v[56:71]
    v_mfma_f32_32x32x16_bf16 v[56:71], v[84:87], v[196:199], v[56:71]
    ds_read_b64_tr_b16 v[24:25], v252 offset:24576
    ds_read_b64_tr_b16 v[26:27], v252 offset:25088
    ds_read_b64_tr_b16 v[28:29], v252 offset:26624
    ds_read_b64_tr_b16 v[30:31], v252 offset:27136
    s_add_u32 m0, s93, 16384
    s_add_u32 s82, s94, 131072
    buffer_load_dwordx4 v9, s[48:51], s82 offen lds
    s_add_u32 m0, s93, 17408
    s_add_u32 s82, s94, 139264
    buffer_load_dwordx4 v9, s[48:51], s82 offen lds
    s_waitcnt lgkmcnt(8)
    v_mfma_f32_32x32x16_bf16 v[56:71], v[88:91], v[200:203], v[56:71]
    v_mfma_f32_32x32x16_bf16 v[56:71], v[92:95], v[204:207], v[56:71]
    ds_read_b64_tr_b16 v[32:33], v252 offset:28672
    ds_read_b64_tr_b16 v[34:35], v252 offset:29184
    ds_read_b64_tr_b16 v[36:37], v252 offset:30720
    ds_read_b64_tr_b16 v[38:39], v252 offset:31232
    s_add_u32 m0, s93, 18432
    s_add_u32 s82, s94, 147456
    buffer_load_dwordx4 v9, s[48:51], s82 offen lds
    s_add_u32 m0, s93, 19456
    s_add_u32 s82, s94, 155648
    buffer_load_dwordx4 v9, s[48:51], s82 offen lds
    s_waitcnt lgkmcnt(8)
    v_mfma_f32_32x32x16_bf16 v[56:71], v[96:99], v[208:211], v[56:71]
    v_mfma_f32_32x32x16_bf16 v[56:71], v[100:103], v[212:215], v[56:71]
    s_add_u32 m0, s93, 32768
    s_add_u32 s82, s94, 262144
    buffer_load_dwordx4 v9, s[48:51], s82 offen lds
    s_add_u32 m0, s93, 33792
    s_add_u32 s82, s94, 270336
    buffer_load_dwordx4 v9, s[48:51], s82 offen lds
    s_cmp_lg_u32 s78, 2
    s_cbranch_scc1 Lonly_68
    s_mov_b32 s81, 557056
    buffer_load_dword v249, v254, s[56:59], s81 offen sc1
Lonly_68:
    s_cmp_lg_u32 s78, 0
    s_cbranch_scc1 Lonly_69
    s_mov_b32 s81, 557056
    buffer_load_dword v249, v235, s[56:59], s81 offen sc1
Lonly_69:
    s_waitcnt lgkmcnt(4)
    v_mfma_f32_32x32x16_bf16 v[56:71], v[24:27], v[216:219], v[56:71]
    v_mfma_f32_32x32x16_bf16 v[56:71], v[28:31], v[220:223], v[56:71]
    s_add_u32 m0, s93, 34816
    s_add_u32 s82, s94, 278528
    buffer_load_dwordx4 v9, s[48:51], s82 offen lds
    s_add_u32 m0, s93, 35840
    s_add_u32 s82, s94, 286720
    buffer_load_dwordx4 v9, s[48:51], s82 offen lds
    s_waitcnt lgkmcnt(0)
    v_mfma_f32_32x32x16_bf16 v[56:71], v[32:35], v[224:227], v[56:71]
    v_mfma_f32_32x32x16_bf16 v[56:71], v[36:39], v[228:231], v[56:71]
    s_setprio 2
    s_lshl_b32 s81, s80, 13
    v_add_u32 v4, s81, v7
    v_xor_b32 v5, 64, v4
    v_add_u32 v6, s81, v6
    v_xor_b32 v252, 64, v6
    ds_read_b64_tr_b16 v[72:73], v4 offset:0
    ds_read_b64_tr_b16 v[74:75], v4 offset:1024
    ds_read_b64_tr_b16 v[76:77], v5 offset:0
    ds_read_b64_tr_b16 v[78:79], v5 offset:1024
    ds_read_b64_tr_b16 v[80:81], v4 offset:2048
    ds_read_b64_tr_b16 v[82:83], v4 offset:3072
    ds_read_b64_tr_b16 v[84:85], v5 offset:2048
    ds_read_b64_tr_b16 v[86:87], v5 offset:3072
    ds_read_b64_tr_b16 v[88:89], v4 offset:4096
    ds_read_b64_tr_b16 v[90:91], v4 offset:5120
    ds_read_b64_tr_b16 v[92:93], v5 offset:4096
    ds_read_b64_tr_b16 v[94:95], v5 offset:5120
    ds_read_b64_tr_b16 v[96:97], v4 offset:6144
    ds_read_b64_tr_b16 v[98:99], v4 offset:7168
    ds_read_b64_tr_b16 v[100:101], v5 offset:6144
    ds_read_b64_tr_b16 v[102:103], v5 offset:7168
    s_cmp_lg_u32 s78, 2
    s_cbranch_scc1 Lonly_70
    s_waitcnt vmcnt(0)
    v_cmp_ne_u32 vcc, s76, v249
    s_cbranch_vccnz Lpf_71
Lpfd_72:
    s_and_b32 s84, s73, 3
    s_lshl_b32 s81, s74, 2
    s_add_u32 s84, s81, s84
    s_lshl_b32 s81, s84, 3
    s_lshr_b32 s83, s73, 2
    s_add_u32 s81, s81, s83
    s_mul_i32 s81, s81, 10240
    s_add_u32 s81, s81, 1048576
    buffer_load_dwordx4 v[168:171], v234, s[56:59], s81 offen offset:0 sc1
    buffer_load_dwordx4 v[172:175], v234, s[56:59], s81 offen offset:640 sc1
    buffer_load_dwordx4 v[176:179], v234, s[56:59], s81 offen offset:1280 sc1
    buffer_load_dwordx4 v[180:183], v234, s[56:59], s81 offen offset:1920 sc1
    s_add_u32 s81, s81, 2560
    buffer_load_dwordx4 v[184:187], v234, s[56:59], s81 offen offset:0 sc1
    buffer_load_dwordx4 v[188:191], v234, s[56:59], s81 offen offset:640 sc1
    buffer_load_dwordx4 v[192:195], v234, s[56:59], s81 offen offset:1280 sc1
    buffer_load_dwordx4 v[196:199], v234, s[56:59], s81 offen offset:1920 sc1
    s_add_u32 s81, s81, 2560
    buffer_load_dwordx4 v[200:203], v234, s[56:59], s81 offen offset:0 sc1
    buffer_load_dwordx4 v[204:207], v234, s[56:59], s81 offen offset:640 sc1
    buffer_load_dwordx4 v[208:211], v234, s[56:59], s81 offen offset:1280 sc1
    buffer_load_dwordx4 v[212:215], v234, s[56:59], s81 offen offset:1920 sc1
    s_add_u32 s81, s81, 2560
    buffer_load_dwordx4 v[216:219], v234, s[56:59], s81 offen offset:0 sc1
    buffer_load_dwordx4 v[220:223], v234, s[56:59], s81 offen offset:640 sc1
    buffer_load_dwordx4 v[224:227], v234, s[56:59], s81 offen offset:1280 sc1
    buffer_load_dwordx4 v[228:231], v234, s[56:59], s81 offen offset:1920 sc1
Lonly_70:
    v_cvt_pk_bf16_f32 v104, v56, v57
    v_cvt_pk_bf16_f32 v105, v58, v59
    v_cvt_pk_bf16_f32 v106, v60, v61
    v_cvt_pk_bf16_f32 v107, v62, v63
    v_cvt_pk_bf16_f32 v108, v64, v65
    v_cvt_pk_bf16_f32 v109, v66, v67
    v_cvt_pk_bf16_f32 v110, v68, v69
    v_cvt_pk_bf16_f32 v111, v70, v71
    s_setprio 0
    v_mfma_f32_32x32x16_bf16 v[120:135], v[16:19], v[104:107], 0
    v_mfma_f32_32x32x16_bf16 v[144:159], v[20:23], v[108:111], 0
    s_setprio 2
    s_nop 9
    v_exp_f32 v120, v120
    v_exp_f32 v121, v121
    v_exp_f32 v122, v122
    v_exp_f32 v123, v123
    v_exp_f32 v124, v124
    v_exp_f32 v125, v125
    v_exp_f32 v126, v126
    v_exp_f32 v127, v127
    v_exp_f32 v128, v128
    v_exp_f32 v129, v129
    v_exp_f32 v130, v130
    v_exp_f32 v131, v131
    v_exp_f32 v132, v132
    v_exp_f32 v133, v133
    v_exp_f32 v134, v134
    v_exp_f32 v135, v135
    v_pk_add_f32 v[136:137], v[120:121], v[122:123]
    v_pk_add_f32 v[138:139], v[124:125], v[126:127]
    v_pk_add_f32 v[136:137], v[136:137], v[128:129]
    v_pk_add_f32 v[138:139], v[138:139], v[130:131]
    v_pk_add_f32 v[136:137], v[136:137], v[132:133]
    v_pk_add_f32 v[138:139], v[138:139], v[134:135]
    v_pk_add_f32 v[136:137], v[136:137], v[138:139]
    v_add_f32 v136, v136, v137
    v_subrev_u32 v137, 0x2b800000, v136
    v_cmp_lt_u32 vcc, 0x3c000000, v137
    s_cbranch_vccnz Lff_73
Lffb_74:
    v_rcp_f32 v136, v136
    s_nop 0
    v_pk_mul_f32 v[120:121], v[120:121], v[136:137] op_sel_hi:[1,0]
    v_pk_mul_f32 v[122:123], v[122:123], v[136:137] op_sel_hi:[1,0]
    v_pk_mul_f32 v[124:125], v[124:125], v[136:137] op_sel_hi:[1,0]
    v_pk_mul_f32 v[126:127], v[126:127], v[136:137] op_sel_hi:[1,0]
    v_pk_mul_f32 v[128:129], v[128:129], v[136:137] op_sel_hi:[1,0]
    v_pk_mul_f32 v[130:131], v[130:131], v[136:137] op_sel_hi:[1,0]
    v_pk_mul_f32 v[132:133], v[132:133], v[136:137] op_sel_hi:[1,0]
    v_pk_mul_f32 v[134:135], v[134:135], v[136:137] op_sel_hi:[1,0]
    v_cvt_pk_bf16_f32 v24, v120, v121
    v_cvt_pk_bf16_f32 v25, v122, v123
    v_cvt_pk_bf16_f32 v26, v124, v125
    v_cvt_pk_bf16_f32 v27, v126, v127
    v_cvt_pk_bf16_f32 v28, v128, v129
    v_cvt_pk_bf16_f32 v29, v130, v131
    v_cvt_pk_bf16_f32 v30, v132, v133
    v_cvt_pk_bf16_f32 v31, v134, v135
    s_cmp_lg_u32 s78, 2
    s_cbranch_scc1 Lonly_75
    s_and_b32 s81, s73, 3
    s_lshl_b32 s82, s74, 2
    s_add_u32 s81, s81, s82
    s_lshl_b32 s81, s81, 2
    s_lshr_b32 s82, s73, 3
    s_add_u32 s81, s81, s82
    s_lshl_b32 s81, s81, 9
    s_and_b32 s82, s73, 4
    s_lshl_b32 s82, s82, 5
    s_add_u32 s81, s81, s82
    s_add_u32 s81, s81, 131072
    s_waitcnt vmcnt(0)
    v_pk_add_f32 v[168:169], v[168:169], v[200:201]
    v_pk_add_f32 v[170:171], v[170:171], v[202:203]
    v_pk_add_f32 v[172:173], v[172:173], v[204:205]
    v_pk_add_f32 v[174:175], v[174:175], v[206:207]
    v_pk_add_f32 v[176:177], v[176:177], v[208:209]
    v_pk_add_f32 v[178:179], v[178:179], v[210:211]
    v_pk_add_f32 v[180:181], v[180:181], v[212:213]
    v_pk_add_f32 v[182:183], v[182:183], v[214:215]
    v_pk_add_f32 v[184:185], v[184:185], v[216:217]
    v_pk_add_f32 v[186:187], v[186:187], v[218:219]
    v_pk_add_f32 v[188:189], v[188:189], v[220:221]
    v_pk_add_f32 v[190:191], v[190:191], v[222:223]
    v_pk_add_f32 v[192:193], v[192:193], v[224:225]
    v_pk_add_f32 v[194:195], v[194:195], v[226:227]
    v_pk_add_f32 v[196:197], v[196:197], v[228:229]
    v_pk_add_f32 v[198:199], v[198:199], v[230:231]
    v_pk_add_f32 v[168:169], v[168:169], v[184:185]
    v_pk_add_f32 v[170:171], v[170:171], v[186:187]
    v_pk_add_f32 v[172:173], v[172:173], v[188:189]
    v_pk_add_f32 v[174:175], v[174:175], v[190:191]
    v_pk_add_f32 v[176:177], v[176:177], v[192:193]
    v_pk_add_f32 v[178:179], v[178:179], v[194:195]
    v_pk_add_f32 v[180:181], v[180:181], v[196:197]
    v_pk_add_f32 v[182:183], v[182:183], v[198:199]
    v_pk_add_f32 v[168:169], v[168:169], v[176:177]
    v_pk_add_f32 v[170:171], v[170:171], v[178:179]
    v_pk_add_f32 v[172:173], v[172:173], v[180:181]
    v_pk_add_f32 v[174:175], v[174:175], v[182:183]
    v_add_f32 v168, v168, v172
    v_add_f32 v169, v169, v173
    v_add_f32 v170, v170, v174
    v_add_f32 v171, v171, v175
    s_nop 0
    v_permlane32_swap_b32 v168, v170
    v_permlane32_swap_b32 v169, v171
    v_add_f32 v168, v168, v170
    v_add_f32 v169, v169, v171
    v_cvt_pk_bf16_f32 v15, v168, v169
    v_min_u32 v15, -2, v15
    buffer_store_dword v15, v255, s[56:59], s81 offen sc1
Lonly_75:
    s_cmp_lg_u32 s78, 0
    s_cbranch_scc1 Lonly_76
    s_waitcnt vmcnt(0)
    v_cmp_ne_u32 vcc, s76, v249
    s_cbranch_vccnz Lpf_77
Lpfd_78:
Lonly_76:
    s_mov_b64 exec, 1
    ds_add_u32 v2, v1 offset:68
    s_mov_b64 exec, -1
    v_exp_f32 v144, v144
    v_exp_f32 v145, v145
    v_exp_f32 v146, v146
    v_exp_f32 v147, v147
    v_exp_f32 v148, v148
    v_exp_f32 v149, v149
    v_exp_f32 v150, v150
    v_exp_f32 v151, v151
    v_exp_f32 v152, v152
    v_exp_f32 v153, v153
    v_exp_f32 v154, v154
    v_exp_f32 v155, v155
    v_exp_f32 v156, v156
    v_exp_f32 v157, v157
    v_exp_f32 v158, v158
    v_exp_f32 v159, v159
    v_pk_add_f32 v[136:137], v[144:145], v[146:147]
    v_pk_add_f32 v[138:139], v[148:149], v[150:151]
    v_pk_add_f32 v[136:137], v[136:137], v[152:153]
    v_pk_add_f32 v[138:139], v[138:139], v[154:155]
    v_pk_add_f32 v[136:137], v[136:137], v[156:157]
    v_pk_add_f32 v[138:139], v[138:139], v[158:159]
    v_pk_add_f32 v[136:137], v[136:137], v[138:139]
    v_add_f32 v136, v136, v137
    v_subrev_u32 v137, 0x2b800000, v136
    v_cmp_lt_u32 vcc, 0x3c000000, v137
    s_cbranch_vccnz Lff_79
Lffb_80:
    v_rcp_f32 v136, v136
    s_nop 0
    v_pk_mul_f32 v[144:145], v[144:145], v[136:137] op_sel_hi:[1,0]
    v_pk_mul_f32 v[146:147], v[146:147], v[136:137] op_sel_hi:[1,0]
    v_pk_mul_f32 v[148:149], v[148:149], v[136:137] op_sel_hi:[1,0]
    v_pk_mul_f32 v[150:151], v[150:151], v[136:137] op_sel_hi:[1,0]
    v_pk_mul_f32 v[152:153], v[152:153], v[136:137] op_sel_hi:[1,0]
    v_pk_mul_f32 v[154:155], v[154:155], v[136:137] op_sel_hi:[1,0]
    v_pk_mul_f32 v[156:157], v[156:157], v[136:137] op_sel_hi:[1,0]
    v_pk_mul_f32 v[158:159], v[158:159], v[136:137] op_sel_hi:[1,0]
    v_cvt_pk_bf16_f32 v32, v144, v145
    v_cvt_pk_bf16_f32 v33, v146, v147
    v_cvt_pk_bf16_f32 v34, v148, v149
    v_cvt_pk_bf16_f32 v35, v150, v151
    v_cvt_pk_bf16_f32 v36, v152, v153
    v_cvt_pk_bf16_f32 v37, v154, v155
    v_cvt_pk_bf16_f32 v38, v156, v157
    v_cvt_pk_bf16_f32 v39, v158, v159
    s_cmp_lg_u32 s78, 3
    s_cbranch_scc1 Lonly_81
    s_mov_b32 s87, 3
    v_mov_b32 v233, v12
    s_call_b64 s[88:89], L_fin
    s_nop 1
Lonly_81:
    s_cmp_lg_u32 s78, 2
    s_cbranch_scc1 Lonly_82
    v_add_u32 v13, 161280, v251
    ds_write_b32 v13, v11
Lonly_82:
    ds_read_b32 v3, v2 offset:68
    s_waitcnt lgkmcnt(0)
    v_readfirstlane_b32 s81, v3
    s_cmp_lt_u32 s81, 4
    s_cbranch_scc1 Lsbr_84
Lsbd_83:
    s_add_u32 m0, s93, 107520
    s_add_u32 s82, s94, 393216
    buffer_load_dwordx4 v9, s[52:55], s82 offen lds
    s_add_u32 m0, s93, 108544
    s_add_u32 s82, s94, 401408
    buffer_load_dwordx4 v9, s[52:55], s82 offen lds
    s_add_u32 m0, s93, 109568
    s_add_u32 s82, s94, 409600
    buffer_load_dwordx4 v9, s[52:55], s82 offen lds
    s_add_u32 m0, s93, 110592
    s_add_u32 s82, s94, 417792
    buffer_load_dwordx4 v9, s[52:55], s82 offen lds
    s_add_u32 m0, s93, 0
    s_add_u32 s82, s94, 0
    buffer_load_dwordx4 v9, s[48:51], s82 offen lds
    s_add_u32 m0, s93, 1024
    s_add_u32 s82, s94, 8192
    buffer_load_dwordx4 v9, s[48:51], s82 offen lds
    s_add_u32 m0, s93, 2048
    s_add_u32 s82, s94, 16384
    buffer_load_dwordx4 v9, s[48:51], s82 offen lds
    s_add_u32 m0, s93, 3072
    s_add_u32 s82, s94, 24576
    buffer_load_dwordx4 v9, s[48:51], s82 offen lds
    s_add_u32 m0, s93, 49152
    s_add_u32 s82, s94, 393216
    buffer_load_dwordx4 v9, s[48:51], s82 offen lds
    s_add_u32 m0, s93, 50176
    s_add_u32 s82, s94, 401408
    buffer_load_dwordx4 v9, s[48:51], s82 offen lds
    s_add_u32 m0, s93, 51200
    s_add_u32 s82, s94, 409600
    buffer_load_dwordx4 v9, s[48:51], s82 offen lds
    s_add_u32 m0, s93, 52224
    s_add_u32 s82, s94, 417792
    buffer_load_dwordx4 v9, s[48:51], s82 offen lds
    s_lshl_b32 s84, s74, 2
    s_lshl_b32 s82, s80, 1
    s_add_u32 s84, s84, s82
    s_mul_i32 s85, s84, 2048
    s_add_u32 s85, s85, 131072
    s_lshl_b32 s95, s73, 1
    s_add_u32 s95, s95, s79
    s_lshl_b32 s95, s95, 16
    s_add_u32 s95, s95, 4194304
    s_lshl_b32 s84, s84, 10
    s_add_u32 s84, s84, s95
    s_add_u32 s84, s84, 32768
    v_sub_f32 v15, 1.0, v11
    s_mov_b32 s93, s95
    s_lshl_b32 s81, s80, 12
    s_add_u32 s94, s93, s81
Ltk_85:
    buffer_load_dword v168, v251, s[56:59], s85 offen offset:0 sc1
    buffer_load_dword v169, v251, s[56:59], s85 offen offset:256 sc1
    buffer_load_dword v170, v251, s[56:59], s85 offen offset:512 sc1
    buffer_load_dword v171, v251, s[56:59], s85 offen offset:768 sc1
    buffer_load_dword v172, v251, s[56:59], s85 offen offset:1024 sc1
    buffer_load_dword v173, v251, s[56:59], s85 offen offset:1280 sc1
    buffer_load_dword v174, v251, s[56:59], s85 offen offset:1536 sc1
    buffer_load_dword v175, v251, s[56:59], s85 offen offset:1792 sc1
    buffer_load_dword v176, v251, s[56:59], s85 offen offset:2048 sc1
    buffer_load_dword v177, v251, s[56:59], s85 offen offset:2304 sc1
    buffer_load_dword v178, v251, s[56:59], s85 offen offset:2560 sc1
    buffer_load_dword v179, v251, s[56:59], s85 offen offset:2816 sc1
    buffer_load_dword v180, v251, s[56:59], s85 offen offset:3072 sc1
    buffer_load_dword v181, v251, s[56:59], s85 offen offset:3328 sc1
    buffer_load_dword v182, v251, s[56:59], s85 offen offset:3584 sc1
    buffer_load_dword v183, v251, s[56:59], s85 offen offset:3840 sc1
Ltkw_87:
    s_waitcnt vmcnt(0)
    v_max_u32 v3, v168, v169
    v_max3_u32 v3, v3, v170, v171
    v_max3_u32 v3, v3, v172, v173
    v_max3_u32 v3, v3, v174, v175
    v_max3_u32 v3, v3, v176, v177
    v_max3_u32 v3, v3, v178, v179
    v_max3_u32 v3, v3, v180, v181
    v_max3_u32 v3, v3, v182, v183
    v_cmp_eq_u32 vcc, -1, v3
    s_cbranch_vccz Ltkd_86
    s_cmp_eq_u32 s77, 0
    s_cbranch_scc1 Ltkd_86
    s_sub_u32 s77, s77, 1
    s_sleep 6
    s_branch Ltk_85
Ltkd_86:
    s_mov_b64 exec, 1
    ds_add_u32 v2, v1 offset:24
    s_mov_b64 exec, -1
    s_setprio 0
    v_mfma_f32_32x32x16_bf16 v[184:199], v[168:171], v[24:27], 0
    v_mfma_f32_32x32x16_bf16 v[184:199], v[172:175], v[28:31], v[184:199]
    v_mfma_f32_32x32x16_bf16 v[200:215], v[176:179], v[32:35], 0
    v_mfma_f32_32x32x16_bf16 v[200:215], v[180:183], v[36:39], v[200:215]
    s_setprio 2
    s_nop 8
    v_add_f32 v192, 0x358637bd, v192
    v_rcp_f32 v192, v192
    s_nop 0
    v_mul_f32 v192, v192, v15
    v_pk_mul_f32 v[184:185], v[184:185], v[192:193] op_sel_hi:[1,0]
    v_pk_mul_f32 v[186:187], v[186:187], v[192:193] op_sel_hi:[1,0]
    v_pk_mul_f32 v[188:189], v[188:189], v[192:193] op_sel_hi:[1,0]
    v_pk_mul_f32 v[190:191], v[190:191], v[192:193] op_sel_hi:[1,0]
    v_cvt_pk_bf16_f32 v196, v184, v185
    v_cvt_pk_bf16_f32 v197, v186, v187
    v_cvt_pk_bf16_f32 v198, v188, v189
    v_cvt_pk_bf16_f32 v199, v190, v191
    v_min_u32 v196, -2, v196
    s_cmp_lt_u32 s91, 64
    s_cbranch_scc1 Lst_88
    buffer_store_dwordx4 v[196:199], v10, s[56:59], s84 offen offset:0 sc1
    s_branch Lst_89
Lst_88:
    buffer_store_dwordx4 v[196:199], v10, s[56:59], s84 offen offset:0 nt
Lst_89:
    v_add_f32 v208, 0x358637bd, v208
    v_rcp_f32 v208, v208
    s_nop 0
    v_mul_f32 v208, v208, v15
    v_pk_mul_f32 v[200:201], v[200:201], v[208:209] op_sel_hi:[1,0]
    v_pk_mul_f32 v[202:203], v[202:203], v[208:209] op_sel_hi:[1,0]
    v_pk_mul_f32 v[204:205], v[204:205], v[208:209] op_sel_hi:[1,0]
    v_pk_mul_f32 v[206:207], v[206:207], v[208:209] op_sel_hi:[1,0]
    v_cvt_pk_bf16_f32 v212, v200, v201
    v_cvt_pk_bf16_f32 v213, v202, v203
    v_cvt_pk_bf16_f32 v214, v204, v205
    v_cvt_pk_bf16_f32 v215, v206, v207
    v_min_u32 v212, -2, v212
    s_cmp_lt_u32 s91, 64
    s_cbranch_scc1 Lst_90
    buffer_store_dwordx4 v[212:215], v10, s[56:59], s84 offen offset:1024 sc1
    s_branch Lst_91
Lst_90:
    buffer_store_dwordx4 v[212:215], v10, s[56:59], s84 offen offset:1024 nt
Lst_91:
    s_mov_b64 exec, 1
    ds_add_u32 v2, v1 offset:72
    s_mov_b64 exec, -1
    v_bfe_u32 v13, v0, 2, 2
    v_and_b32 v14, 3, v0
    v_lshl_add_u32 v13, v13, 3, v14
    v_lshlrev_b32 v248, 10, v13
    s_cmp_eq_u32 s79, 1
    s_cbranch_scc1 L_half1
    s_cmp_lg_u32 s78, 1
    s_cbranch_scc1 Lonly_92
    s_mov_b32 s87, 4
    v_mov_b32 v233, v12
    s_call_b64 s[88:89], L_fin
    s_nop 1
Lonly_92:
Ltk_93:
    s_add_u32 s82, s94, 0
    buffer_load_dwordx4 v[104:107], v10, s[56:59], s82 offen offset:0 sc1
    buffer_load_dwordx4 v[108:111], v10, s[56:59], s82 offen offset:1024 sc1
    buffer_load_dwordx4 v[112:115], v10, s[56:59], s82 offen offset:2048 sc1
    buffer_load_dwordx4 v[116:119], v10, s[56:59], s82 offen offset:3072 sc1
    s_add_u32 s82, s94, 8192
    buffer_load_dwordx4 v[120:123], v10, s[56:59], s82 offen offset:0 sc1
    buffer_load_dwordx4 v[124:127], v10, s[56:59], s82 offen offset:1024 sc1
    buffer_load_dwordx4 v[128:131], v10, s[56:59], s82 offen offset:2048 sc1
    buffer_load_dwordx4 v[132:135], v10, s[56:59], s82 offen offset:3072 sc1
    s_add_u32 s82, s94, 16384
    buffer_load_dwordx4 v[136:139], v10, s[56:59], s82 offen offset:0 sc1
    buffer_load_dwordx4 v[140:143], v10, s[56:59], s82 offen offset:1024 sc1
    buffer_load_dwordx4 v[144:147], v10, s[56:59], s82 offen offset:2048 sc1
    buffer_load_dwordx4 v[148:151], v10, s[56:59], s82 offen offset:3072 sc1
    s_add_u32 s82, s94, 24576
    buffer_load_dwordx4 v[152:155], v10, s[56:59], s82 offen offset:0 sc1
    buffer_load_dwordx4 v[156:159], v10, s[56:59], s82 offen offset:1024 sc1
    buffer_load_dwordx4 v[160:163], v10, s[56:59], s82 offen offset:2048 sc1
    buffer_load_dwordx4 v[164:167], v10, s[56:59], s82 offen offset:3072 sc1
Ltkw_95:
    s_waitcnt vmcnt(0)
    v_max_u32 v3, v104, v108
    v_max3_u32 v3, v3, v112, v116
    v_max3_u32 v3, v3, v120, v124
    v_max3_u32 v3, v3, v128, v132
    v_max3_u32 v3, v3, v136, v140
    v_max3_u32 v3, v3, v144, v148
    v_max3_u32 v3, v3, v152, v156
    v_max3_u32 v3, v3, v160, v164
    v_cmp_eq_u32 vcc, -1, v3
    s_cbranch_vccz Ltkd_94
    s_cmp_eq_u32 s77, 0
    s_cbranch_scc1 Ltkd_94
    s_sub_u32 s77, s77, 1
    s_sleep 8
    s_branch Ltk_93
Ltkd_94:
    ds_read_b32 v3, v2 offset:24
    s_waitcnt lgkmcnt(0)
    v_readfirstlane_b32 s81, v3
    s_cmp_lt_u32 s81, 4
    s_cbranch_scc1 Lsbr_97
Lsbd_96:
    ds_read_b64_tr_b16 v[16:17], v4 offset:0
    ds_read_b64_tr_b16 v[18:19], v4 offset:1024
    ds_read_b64_tr_b16 v[20:21], v5 offset:0
    ds_read_b64_tr_b16 v[22:23], v5 offset:1024
    ds_read_b64_tr_b16 v[24:25], v4 offset:2048
    ds_read_b64_tr_b16 v[26:27], v4 offset:3072
    ds_read_b64_tr_b16 v[28:29], v5 offset:2048
    ds_read_b64_tr_b16 v[30:31], v5 offset:3072
    ds_read_b64_tr_b16 v[32:33], v4 offset:4096
    ds_read_b64_tr_b16 v[34:35], v4 offset:5120
    ds_read_b64_tr_b16 v[36:37], v5 offset:4096
    ds_read_b64_tr_b16 v[38:39], v5 offset:5120
    s_setprio 0
    s_waitcnt lgkmcnt(8)
    v_mfma_f32_32x32x16_bf16 v[40:55], v[16:19], v[104:107], 0
    v_mfma_f32_32x32x16_bf16 v[56:71], v[20:23], v[104:107], 0
    ds_read_b64_tr_b16 v[236:237], v4 offset:6144
    ds_read_b64_tr_b16 v[238:239], v4 offset:7168
    ds_read_b64_tr_b16 v[240:241], v5 offset:6144
    ds_read_b64_tr_b16 v[242:243], v5 offset:7168
    s_waitcnt lgkmcnt(8)
    v_mfma_f32_32x32x16_bf16 v[40:55], v[24:27], v[108:111], v[40:55]
    v_mfma_f32_32x32x16_bf16 v[56:71], v[28:31], v[108:111], v[56:71]
    ds_read_b64_tr_b16 v[16:17], v4 offset:16384
    ds_read_b64_tr_b16 v[18:19], v4 offset:17408
    ds_read_b64_tr_b16 v[20:21], v5 offset:16384
    ds_read_b64_tr_b16 v[22:23], v5 offset:17408
    s_waitcnt lgkmcnt(8)
    v_mfma_f32_32x32x16_bf16 v[40:55], v[32:35], v[112:115], v[40:55]
    v_mfma_f32_32x32x16_bf16 v[56:71], v[36:39], v[112:115], v[56:71]
    ds_read_b64_tr_b16 v[24:25], v4 offset:18432
    ds_read_b64_tr_b16 v[26:27], v4 offset:19456
    ds_read_b64_tr_b16 v[28:29], v5 offset:18432
    ds_read_b64_tr_b16 v[30:31], v5 offset:19456
    s_waitcnt lgkmcnt(8)
    v_mfma_f32_32x32x16_bf16 v[40:55], v[236:239], v[116:119], v[40:55]
    v_mfma_f32_32x32x16_bf16 v[56:71], v[240:243], v[116:119], v[56:71]
    ds_read_b64_tr_b16 v[32:33], v4 offset:20480
    ds_read_b64_tr_b16 v[34:35], v4 offset:21504
    ds_read_b64_tr_b16 v[36:37], v5 offset:20480
    ds_read_b64_tr_b16 v[38:39], v5 offset:21504
    s_waitcnt lgkmcnt(8)
    v_mfma_f32_32x32x16_bf16 v[40:55], v[16:19], v[120:123], v[40:55]
    v_mfma_f32_32x32x16_bf16 v[56:71], v[20:23], v[120:123], v[56:71]
    ds_read_b64_tr_b16 v[236:237], v4 offset:22528
    ds_read_b64_tr_b16 v[238:239], v4 offset:23552
    ds_read_b64_tr_b16 v[240:241], v5 offset:22528
    ds_read_b64_tr_b16 v[242:243], v5 offset:23552
    s_waitcnt lgkmcnt(8)
    v_mfma_f32_32x32x16_bf16 v[40:55], v[24:27], v[124:127], v[40:55]
    v_mfma_f32_32x32x16_bf16 v[56:71], v[28:31], v[124:127], v[56:71]
    ds_read_b64_tr_b16 v[16:17], v4 offset:32768
    ds_read_b64_tr_b16 v[18:19], v4 offset:33792
    ds_read_b64_tr_b16 v[20:21], v5 offset:32768
    ds_read_b64_tr_b16 v[22:23], v5 offset:33792
    s_waitcnt lgkmcnt(8)
    v_mfma_f32_32x32x16_bf16 v[40:55], v[32:35], v[128:131], v[40:55]
    v_mfma_f32_32x32x16_bf16 v[56:71], v[36:39], v[128:131], v[56:71]
    ds_read_b64_tr_b16 v[24:25], v4 offset:34816
    ds_read_b64_tr_b16 v[26:27], v4 offset:35840
    ds_read_b64_tr_b16 v[28:29], v5 offset:34816
    ds_read_b64_tr_b16 v[30:31], v5 offset:35840
    s_waitcnt lgkmcnt(8)
    v_mfma_f32_32x32x16_bf16 v[40:55], v[236:239], v[132:135], v[40:55]
    v_mfma_f32_32x32x16_bf16 v[56:71], v[240:243], v[132:135], v[56:71]
    ds_read_b64_tr_b16 v[32:33], v4 offset:36864
    ds_read_b64_tr_b16 v[34:35], v4 offset:37888
    ds_read_b64_tr_b16 v[36:37], v5 offset:36864
    ds_read_b64_tr_b16 v[38:39], v5 offset:37888
    s_waitcnt lgkmcnt(8)
    v_mfma_f32_32x32x16_bf16 v[40:55], v[16:19], v[136:139], v[40:55]
    v_mfma_f32_32x32x16_bf16 v[56:71], v[20:23], v[136:139], v[56:71]
    ds_read_b64_tr_b16 v[236:237], v4 offset:38912
    ds_read_b64_tr_b16 v[238:239], v4 offset:39936
    ds_read_b64_tr_b16 v[240:241], v5 offset:38912
    ds_read_b64_tr_b16 v[242:243], v5 offset:39936
    s_waitcnt lgkmcnt(8)
    v_mfma_f32_32x32x16_bf16 v[40:55], v[24:27], v[140:143], v[40:55]
    v_mfma_f32_32x32x16_bf16 v[56:71], v[28:31], v[140:143], v[56:71]
    ds_read_b64_tr_b16 v[16:17], v4 offset:49152
    ds_read_b64_tr_b16 v[18:19], v4 offset:50176
    ds_read_b64_tr_b16 v[20:21], v5 offset:49152
    ds_read_b64_tr_b16 v[22:23], v5 offset:50176
    s_waitcnt lgkmcnt(8)
    v_mfma_f32_32x32x16_bf16 v[40:55], v[32:35], v[144:147], v[40:55]
    v_mfma_f32_32x32x16_bf16 v[56:71], v[36:39], v[144:147], v[56:71]
    ds_read_b64_tr_b16 v[24:25], v4 offset:51200
    ds_read_b64_tr_b16 v[26:27], v4 offset:52224
    ds_read_b64_tr_b16 v[28:29], v5 offset:51200
    ds_read_b64_tr_b16 v[30:31], v5 offset:52224
    s_add_u32 s82, s94, 32768
    buffer_load_dwordx4 v[168:171], v10, s[56:59], s82 offen offset:0 sc1
    buffer_load_dwordx4 v[172:175], v10, s[56:59], s82 offen offset:1024 sc1
    buffer_load_dwordx4 v[176:179], v10, s[56:59], s82 offen offset:2048 sc1
    buffer_load_dwordx4 v[180:183], v10, s[56:59], s82 offen offset:3072 sc1
    s_add_u32 s82, s94, 40960
    buffer_load_dwordx4 v[184:187], v10, s[56:59], s82 offen offset:0 sc1
    buffer_load_dwordx4 v[188:191], v10, s[56:59], s82 offen offset:1024 sc1
    buffer_load_dwordx4 v[192:195], v10, s[56:59], s82 offen offset:2048 sc1
    buffer_load_dwordx4 v[196:199], v10, s[56:59], s82 offen offset:3072 sc1
    s_add_u32 s82, s94, 49152
    buffer_load_dwordx4 v[200:203], v10, s[56:59], s82 offen offset:0 sc1
    buffer_load_dwordx4 v[204:207], v10, s[56:59], s82 offen offset:1024 sc1
    buffer_load_dwordx4 v[208:211], v10, s[56:59], s82 offen offset:2048 sc1
    buffer_load_dwordx4 v[212:215], v10, s[56:59], s82 offen offset:3072 sc1
    s_add_u32 s82, s94, 57344
    buffer_load_dwordx4 v[216:219], v10, s[56:59], s82 offen offset:0 sc1
    buffer_load_dwordx4 v[220:223], v10, s[56:59], s82 offen offset:1024 sc1
    buffer_load_dwordx4 v[224:227], v10, s[56:59], s82 offen offset:2048 sc1
    buffer_load_dwordx4 v[228:231], v10, s[56:59], s82 offen offset:3072 sc1
    s_waitcnt lgkmcnt(8)
    v_mfma_f32_32x32x16_bf16 v[40:55], v[236:239], v[148:151], v[40:55]
    v_mfma_f32_32x32x16_bf16 v[56:71], v[240:243], v[148:151], v[56:71]
    ds_read_b64_tr_b16 v[32:33], v4 offset:53248
    ds_read_b64_tr_b16 v[34:35], v4 offset:54272
    ds_read_b64_tr_b16 v[36:37], v5 offset:53248
    ds_read_b64_tr_b16 v[38:39], v5 offset:54272
    s_waitcnt lgkmcnt(8)
    v_mfma_f32_32x32x16_bf16 v[40:55], v[16:19], v[152:155], v[40:55]
    v_mfma_f32_32x32x16_bf16 v[56:71], v[20:23], v[152:155], v[56:71]
    ds_read_b64_tr_b16 v[236:237], v4 offset:55296
    ds_read_b64_tr_b16 v[238:239], v4 offset:56320
    ds_read_b64_tr_b16 v[240:241], v5 offset:55296
    ds_read_b64_tr_b16 v[242:243], v5 offset:56320
    s_waitcnt lgkmcnt(8)
    v_mfma_f32_32x32x16_bf16 v[40:55], v[24:27], v[156:159], v[40:55]
    v_mfma_f32_32x32x16_bf16 v[56:71], v[28:31], v[156:159], v[56:71]
    s_waitcnt lgkmcnt(4)
    v_mfma_f32_32x32x16_bf16 v[40:55], v[32:35], v[160:163], v[40:55]
    v_mfma_f32_32x32x16_bf16 v[56:71], v[36:39], v[160:163], v[56:71]
    s_waitcnt lgkmcnt(0)
    v_mfma_f32_32x32x16_bf16 v[40:55], v[236:239], v[164:167], v[40:55]
    v_mfma_f32_32x32x16_bf16 v[56:71], v[240:243], v[164:167], v[56:71]
    s_setprio 2
    s_cmp_lg_u32 s78, 0
    s_cbranch_scc1 Lonly_98
    s_mov_b32 s87, 6
    v_mov_b32 v233, v12
    s_call_b64 s[88:89], L_fin
    s_nop 1
Lonly_98:
    s_branch Ltkw_101
Ltk_99:
    s_add_u32 s82, s94, 32768
Lpb_102:
    buffer_load_dword v249, v248, s[56:59], s82 offen offset:1008 sc1
    s_waitcnt vmcnt(0)
    v_cmp_eq_u32 vcc, -1, v249
    s_cbranch_vccz Lpbd_103
    s_cmp_eq_u32 s77, 0
    s_cbranch_scc1 Lpbd_103
    s_sub_u32 s77, s77, 1
    s_sleep 8
    s_branch Lpb_102
Lpbd_103:
    s_add_u32 s82, s94, 32768
    buffer_load_dwordx4 v[168:171], v10, s[56:59], s82 offen offset:0 sc1
    buffer_load_dwordx4 v[172:175], v10, s[56:59], s82 offen offset:1024 sc1
    buffer_load_dwordx4 v[176:179], v10, s[56:59], s82 offen offset:2048 sc1
    buffer_load_dwordx4 v[180:183], v10, s[56:59], s82 offen offset:3072 sc1
    s_add_u32 s82, s94, 40960
    buffer_load_dwordx4 v[184:187], v10, s[56:59], s82 offen offset:0 sc1
    buffer_load_dwordx4 v[188:191], v10, s[56:59], s82 offen offset:1024 sc1
    buffer_load_dwordx4 v[192:195], v10, s[56:59], s82 offen offset:2048 sc1
    buffer_load_dwordx4 v[196:199], v10, s[56:59], s82 offen offset:3072 sc1
    s_add_u32 s82, s94, 49152
    buffer_load_dwordx4 v[200:203], v10, s[56:59], s82 offen offset:0 sc1
    buffer_load_dwordx4 v[204:207], v10, s[56:59], s82 offen offset:1024 sc1
    buffer_load_dwordx4 v[208:211], v10, s[56:59], s82 offen offset:2048 sc1
    buffer_load_dwordx4 v[212:215], v10, s[56:59], s82 offen offset:3072 sc1
    s_add_u32 s82, s94, 57344
    buffer_load_dwordx4 v[216:219], v10, s[56:59], s82 offen offset:0 sc1
    buffer_load_dwordx4 v[220:223], v10, s[56:59], s82 offen offset:1024 sc1
    buffer_load_dwordx4 v[224:227], v10, s[56:59], s82 offen offset:2048 sc1
    buffer_load_dwordx4 v[228:231], v10, s[56:59], s82 offen offset:3072 sc1
Ltkw_101:
    s_waitcnt vmcnt(0)
    v_max_u32 v3, v168, v172
    v_max3_u32 v3, v3, v176, v180
    v_max3_u32 v3, v3, v184, v188
    v_max3_u32 v3, v3, v192, v196
    v_max3_u32 v3, v3, v200, v204
    v_max3_u32 v3, v3, v208, v212
    v_max3_u32 v3, v3, v216, v220
    v_max3_u32 v3, v3, v224, v228
    v_cmp_eq_u32 vcc, -1, v3
    s_cbranch_vccz Ltkd_100
    s_cmp_eq_u32 s77, 0
    s_cbranch_scc1 Ltkd_100
    s_sub_u32 s77, s77, 1
    s_branch Ltk_99
Ltkd_100:
    v_mov_b32 v13, 160816
Lcf_104:
    ds_read_b32 v3, v13
    s_waitcnt lgkmcnt(0)
    v_cmp_eq_u32 vcc, 0, v3
    s_cbranch_vccz Lcfd_105
    s_cmp_eq_u32 s77, 0
    s_cbranch_scc1 Lcfd_105
    s_sub_u32 s77, s77, 1
    s_sleep 2
    s_branch Lcf_104
Lcfd_105:
    ds_read_b64_tr_b16 v[16:17], v252 offset:16384
    ds_read_b64_tr_b16 v[18:19], v252 offset:17408
    ds_read_b64_tr_b16 v[20:21], v252 offset:18432
    ds_read_b64_tr_b16 v[22:23], v252 offset:19456
    ds_read_b64_tr_b16 v[24:25], v252 offset:20480
    ds_read_b64_tr_b16 v[26:27], v252 offset:21504
    ds_read_b64_tr_b16 v[28:29], v252 offset:22528
    ds_read_b64_tr_b16 v[30:31], v252 offset:23552
    ds_read_b64_tr_b16 v[32:33], v252 offset:32768
    ds_read_b64_tr_b16 v[34:35], v252 offset:33792
    ds_read_b64_tr_b16 v[36:37], v252 offset:34816
    ds_read_b64_tr_b16 v[38:39], v252 offset:35840
    v_and_b32 v14, 31, v0
    v_lshlrev_b32 v14, 10, v14
    v_lshrrev_b32 v15, 5, v0
    v_lshl_add_u32 v14, v15, 4, v14
    s_lshl_b32 s85, s73, 16
    s_lshl_b32 s82, s79, 15
    s_add_u32 s85, s85, s82
    s_lshl_b32 s82, s74, 7
    s_add_u32 s85, s85, s82
    s_lshl_b32 s82, s80, 6
    s_add_u32 s85, s85, s82
    s_add_u32 s84, s85, 16384
    s_lshl_b32 s83, s78, 12
    s_add_u32 s81, s83, 74752
    v_add_u32 v254, s81, v10
    s_xor_b32 s83, s83, 4096
    s_add_u32 s81, s83, 74752
    v_add_u32 v253, s81, v10
    s_lshl_b32 s81, s78, 8
    s_add_u32 s81, s81, 159952
    v_mov_b32 v13, s81
    s_branch Ltw_106
.p2align 12, , 1100
Ltw_106:
    ds_read_b32 v3, v13
    s_waitcnt lgkmcnt(0)
    v_cmp_eq_u32 vcc, 0, v3
    s_cbranch_vccz Ltwd_107
    s_cmp_eq_u32 s77, 0
    s_cbranch_scc1 Ltwd_107
    s_sub_u32 s77, s77, 1
    s_sleep 1
    s_branch Ltw_106
Ltwd_107:
    v_mfma_f32_32x32x16_bf16 v[56:71], v[76:79], v[168:171], v[56:71]
    v_mfma_f32_32x32x16_bf16 v[56:71], v[84:87], v[172:175], v[56:71]
    v_mfma_f32_32x32x16_bf16 v[56:71], v[92:95], v[176:179], v[56:71]
    v_mfma_f32_32x32x16_bf16 v[56:71], v[100:103], v[180:183], v[56:71]
    v_mfma_f32_32x32x16_bf16 v[56:71], v[16:19], v[184:187], v[56:71]
    ds_read_b64_tr_b16 v[236:237], v252 offset:36864
    ds_read_b64_tr_b16 v[238:239], v252 offset:37888
    v_mfma_f32_32x32x16_bf16 v[56:71], v[20:23], v[188:191], v[56:71]
    ds_read_b64_tr_b16 v[240:241], v252 offset:38912
    ds_read_b64_tr_b16 v[242:243], v252 offset:39936
    v_mfma_f32_32x32x16_bf16 v[56:71], v[24:27], v[192:195], v[56:71]
    ds_read_b64_tr_b16 v[16:17], v252 offset:0
    ds_read_b64_tr_b16 v[18:19], v252 offset:1024
    v_mfma_f32_32x32x16_bf16 v[56:71], v[28:31], v[196:199], v[56:71]
    ds_read_b64_tr_b16 v[20:21], v252 offset:2048
    ds_read_b64_tr_b16 v[22:23], v252 offset:3072
    v_mfma_f32_32x32x16_bf16 v[56:71], v[32:35], v[200:203], v[56:71]
    ds_read_b64_tr_b16 v[24:25], v252 offset:4096
    ds_read_b64_tr_b16 v[26:27], v252 offset:5120
    v_mfma_f32_32x32x16_bf16 v[56:71], v[36:39], v[204:207], v[56:71]
    ds_read_b64_tr_b16 v[28:29], v252 offset:6144
    ds_read_b64_tr_b16 v[30:31], v252 offset:7168
    s_waitcnt lgkmcnt(10)
    v_mfma_f32_32x32x16_bf16 v[56:71], v[236:239], v[208:211], v[56:71]
    ds_read_b64_tr_b16 v[32:33], v6 offset:16384
    ds_read_b64_tr_b16 v[34:35], v6 offset:17408
    s_waitcnt lgkmcnt(10)
    v_mfma_f32_32x32x16_bf16 v[56:71], v[240:243], v[212:215], v[56:71]
    ds_read_b64_tr_b16 v[36:37], v6 offset:18432
    ds_read_b64_tr_b16 v[38:39], v6 offset:19456
    s_waitcnt lgkmcnt(10)
    v_mfma_f32_32x32x16_bf16 v[56:71], v[16:19], v[216:219], v[56:71]
    ds_read_b64_tr_b16 v[236:237], v6 offset:20480
    ds_read_b64_tr_b16 v[238:239], v6 offset:21504
    s_waitcnt lgkmcnt(10)
    v_mfma_f32_32x32x16_bf16 v[56:71], v[20:23], v[220:223], v[56:71]
    ds_read_b64_tr_b16 v[240:241], v6 offset:22528
    ds_read_b64_tr_b16 v[242:243], v6 offset:23552
    s_waitcnt lgkmcnt(10)
    v_mfma_f32_32x32x16_bf16 v[56:71], v[24:27], v[224:227], v[56:71]
    ds_read_b64_tr_b16 v[16:17], v6 offset:32768
    ds_read_b64_tr_b16 v[18:19], v6 offset:33792
    s_waitcnt lgkmcnt(10)
    v_mfma_f32_32x32x16_bf16 v[56:71], v[28:31], v[228:231], v[56:71]
    ds_read_b64_tr_b16 v[20:21], v6 offset:34816
    ds_read_b64_tr_b16 v[22:23], v6 offset:35840
    v_mfma_f32_32x32x16_bf16 v[40:55], v[72:75], v[168:171], v[40:55]
    v_mfma_f32_32x32x16_bf16 v[40:55], v[80:83], v[172:175], v[40:55]
    s_nop 7
    ds_write_b128 v254, v[56:59] offset:0
    ds_write_b128 v254, v[60:63] offset:1024
    ds_write_b128 v254, v[64:67] offset:2048
    ds_write_b128 v254, v[68:71] offset:3072
    s_mov_b64 exec, 1
    ds_add_u32 v2, v1 offset:80
    s_mov_b64 exec, -1
    v_mfma_f32_32x32x16_bf16 v[40:55], v[88:91], v[176:179], v[40:55]
    v_mfma_f32_32x32x16_bf16 v[40:55], v[96:99], v[180:183], v[40:55]
    s_waitcnt lgkmcnt(15)
    v_mfma_f32_32x32x16_bf16 v[40:55], v[32:35], v[184:187], v[40:55]
    ds_read_b64_tr_b16 v[24:25], v6 offset:36864
    ds_read_b64_tr_b16 v[26:27], v6 offset:37888
    s_waitcnt lgkmcnt(15)
    v_mfma_f32_32x32x16_bf16 v[40:55], v[36:39], v[188:191], v[40:55]
    ds_read_b64_tr_b16 v[28:29], v6 offset:38912
    ds_read_b64_tr_b16 v[30:31], v6 offset:39936
    s_waitcnt lgkmcnt(15)
    v_mfma_f32_32x32x16_bf16 v[40:55], v[236:239], v[192:195], v[40:55]
    ds_read_b64_tr_b16 v[32:33], v6 offset:0
    ds_read_b64_tr_b16 v[34:35], v6 offset:1024
    s_waitcnt lgkmcnt(15)
    v_mfma_f32_32x32x16_bf16 v[40:55], v[240:243], v[196:199], v[40:55]
    ds_read_b64_tr_b16 v[36:37], v6 offset:2048
    ds_read_b64_tr_b16 v[38:39], v6 offset:3072
    s_waitcnt lgkmcnt(15)
    v_mfma_f32_32x32x16_bf16 v[40:55], v[16:19], v[200:203], v[40:55]
    ds_read_b64_tr_b16 v[236:237], v6 offset:4096
    ds_read_b64_tr_b16 v[238:239], v6 offset:5120
    s_waitcnt lgkmcnt(15)
    v_mfma_f32_32x32x16_bf16 v[40:55], v[20:23], v[204:207], v[40:55]
    ds_read_b64_tr_b16 v[240:241], v6 offset:6144
    ds_read_b64_tr_b16 v[242:243], v6 offset:7168
    s_waitcnt lgkmcnt(10)
    v_mfma_f32_32x32x16_bf16 v[40:55], v[24:27], v[208:211], v[40:55]
    ds_read_b32 v3, v2 offset:80
    s_waitcnt lgkmcnt(9)
    v_mfma_f32_32x32x16_bf16 v[40:55], v[28:31], v[212:215], v[40:55]
    s_waitcnt lgkmcnt(7)
    v_mfma_f32_32x32x16_bf16 v[40:55], v[32:35], v[216:219], v[40:55]
    s_waitcnt lgkmcnt(0)
Lsbr_109:
    v_readfirstlane_b32 s81, v3
    s_cmp_ge_u32 s81, 2
    s_cbranch_scc1 Lsbd_108
    s_cmp_eq_u32 s77, 0
    s_cbranch_scc1 Lsbd_108
    s_sub_u32 s77, s77, 1
    ds_read_b32 v3, v2 offset:80
    s_waitcnt lgkmcnt(0)
    s_branch Lsbr_109
Lsbd_108:
    ds_read_b128 v[56:59], v253 offset:0
    ds_read_b128 v[60:63], v253 offset:1024
    ds_read_b128 v[64:67], v253 offset:2048
    ds_read_b128 v[68:71], v253 offset:3072
    v_mfma_f32_32x32x16_bf16 v[40:55], v[36:39], v[220:223], v[40:55]
    v_mfma_f32_32x32x16_bf16 v[40:55], v[236:239], v[224:227], v[40:55]
    v_mfma_f32_32x32x16_bf16 v[40:55], v[240:243], v[228:231], v[40:55]
    s_waitcnt lgkmcnt(0)
    s_nop 10
    v_pk_add_f32 v[40:41], v[40:41], v[56:57]
    v_pk_add_f32 v[42:43], v[42:43], v[58:59]
    v_pk_add_f32 v[44:45], v[44:45], v[60:61]
    v_pk_add_f32 v[46:47], v[46:47], v[62:63]
    v_pk_add_f32 v[48:49], v[48:49], v[64:65]
    v_pk_add_f32 v[50:51], v[50:51], v[66:67]
    v_pk_add_f32 v[52:53], v[52:53], v[68:69]
    v_pk_add_f32 v[54:55], v[54:55], v[70:71]
    v_cvt_pk_bf16_f32 v24, v40, v41
    v_cvt_pk_bf16_f32 v25, v42, v43
    v_cvt_pk_bf16_f32 v26, v44, v45
    v_cvt_pk_bf16_f32 v27, v46, v47
    v_cvt_pk_bf16_f32 v28, v48, v49
    v_cvt_pk_bf16_f32 v29, v50, v51
    v_cvt_pk_bf16_f32 v30, v52, v53
    v_cvt_pk_bf16_f32 v31, v54, v55
    v_permlane32_swap_b32 v24, v26
    v_permlane32_swap_b32 v25, v27
    buffer_store_dwordx4 v[24:27], v14, s[60:63], s85 offen offset:0
    v_permlane32_swap_b32 v28, v30
    v_permlane32_swap_b32 v29, v31
    buffer_store_dwordx4 v[28:31], v14, s[60:63], s85 offen offset:32
    s_endpgm
L_half1:
    s_cmp_lg_u32 s78, 2
    s_cbranch_scc1 Lonly_110
    s_mov_b32 s87, 5
    v_mov_b32 v233, v11
    s_call_b64 s[88:89], L_fin
    s_nop 1
Lonly_110:
    ds_read_b32 v3, v2 offset:72
    s_waitcnt lgkmcnt(0)
    v_readfirstlane_b32 s81, v3
    s_cmp_lt_u32 s81, 4
    s_cbranch_scc1 Lsbr_112
Lsbd_111:
    v_mov_b32 v13, 160820
Lcf_113:
    ds_read_b32 v3, v13
    s_waitcnt lgkmcnt(0)
    v_cmp_eq_u32 vcc, 0, v3
    s_cbranch_vccz Lcfd_114
    s_cmp_eq_u32 s77, 0
    s_cbranch_scc1 Lcfd_114
    s_sub_u32 s77, s77, 1
    s_sleep 2
    s_branch Lcf_113
Lcfd_114:
Ltk_115:
    s_add_u32 s82, s94, 0
    buffer_load_dwordx4 v[168:171], v10, s[56:59], s82 offen offset:0 sc1
    buffer_load_dwordx4 v[172:175], v10, s[56:59], s82 offen offset:1024 sc1
    s_add_u32 s82, s94, 8192
    buffer_load_dwordx4 v[176:179], v10, s[56:59], s82 offen offset:0 sc1
    buffer_load_dwordx4 v[180:183], v10, s[56:59], s82 offen offset:1024 sc1
    s_add_u32 s82, s94, 16384
    buffer_load_dwordx4 v[184:187], v10, s[56:59], s82 offen offset:0 sc1
    buffer_load_dwordx4 v[188:191], v10, s[56:59], s82 offen offset:1024 sc1
    s_add_u32 s82, s94, 24576
    buffer_load_dwordx4 v[192:195], v10, s[56:59], s82 offen offset:0 sc1
    buffer_load_dwordx4 v[196:199], v10, s[56:59], s82 offen offset:1024 sc1
Ltkw_117:
    s_waitcnt vmcnt(0)
    v_max_u32 v3, v168, v172
    v_max3_u32 v3, v3, v176, v180
    v_max3_u32 v3, v3, v184, v188
    v_max3_u32 v3, v3, v192, v196
    v_cmp_eq_u32 vcc, -1, v3
    s_cbranch_vccz Ltkd_116
    s_cmp_eq_u32 s77, 0
    s_cbranch_scc1 Ltkd_116
    s_sub_u32 s77, s77, 1
    s_sleep 3
    s_branch Ltk_115
Ltkd_116:
    ds_read_b64_tr_b16 v[16:17], v4 offset:0
    ds_read_b64_tr_b16 v[18:19], v4 offset:1024
    ds_read_b64_tr_b16 v[20:21], v5 offset:0
    ds_read_b64_tr_b16 v[22:23], v5 offset:1024
    ds_read_b64_tr_b16 v[24:25], v4 offset:2048
    ds_read_b64_tr_b16 v[26:27], v4 offset:3072
    ds_read_b64_tr_b16 v[28:29], v5 offset:2048
    ds_read_b64_tr_b16 v[30:31], v5 offset:3072
    ds_read_b64_tr_b16 v[32:33], v4 offset:16384
    ds_read_b64_tr_b16 v[34:35], v4 offset:17408
    ds_read_b64_tr_b16 v[36:37], v5 offset:16384
    ds_read_b64_tr_b16 v[38:39], v5 offset:17408
    s_setprio 0
    s_waitcnt lgkmcnt(8)
    v_mfma_f32_32x32x16_bf16 v[40:55], v[16:19], v[168:171], 0
    v_mfma_f32_32x32x16_bf16 v[56:71], v[20:23], v[168:171], 0
    ds_read_b64_tr_b16 v[236:237], v4 offset:18432
    ds_read_b64_tr_b16 v[238:239], v4 offset:19456
    ds_read_b64_tr_b16 v[240:241], v5 offset:18432
    ds_read_b64_tr_b16 v[242:243], v5 offset:19456
    s_waitcnt lgkmcnt(8)
    v_mfma_f32_32x32x16_bf16 v[40:55], v[24:27], v[172:175], v[40:55]
    v_mfma_f32_32x32x16_bf16 v[56:71], v[28:31], v[172:175], v[56:71]
    ds_read_b64_tr_b16 v[16:17], v4 offset:32768
    ds_read_b64_tr_b16 v[18:19], v4 offset:33792
    ds_read_b64_tr_b16 v[20:21], v5 offset:32768
    ds_read_b64_tr_b16 v[22:23], v5 offset:33792
    s_add_u32 s82, s94, 32768
    buffer_load_dwordx4 v[104:107], v10, s[56:59], s82 offen offset:0 sc1
    buffer_load_dwordx4 v[108:111], v10, s[56:59], s82 offen offset:1024 sc1
    buffer_load_dwordx4 v[112:115], v10, s[56:59], s82 offen offset:2048 sc1
    buffer_load_dwordx4 v[116:119], v10, s[56:59], s82 offen offset:3072 sc1
    s_add_u32 s82, s94, 40960
    buffer_load_dwordx4 v[120:123], v10, s[56:59], s82 offen offset:0 sc1
    buffer_load_dwordx4 v[124:127], v10, s[56:59], s82 offen offset:1024 sc1
    buffer_load_dwordx4 v[128:131], v10, s[56:59], s82 offen offset:2048 sc1
    buffer_load_dwordx4 v[132:135], v10, s[56:59], s82 offen offset:3072 sc1
    s_add_u32 s82, s94, 49152
    buffer_load_dwordx4 v[136:139], v10, s[56:59], s82 offen offset:0 sc1
    buffer_load_dwordx4 v[140:143], v10, s[56:59], s82 offen offset:1024 sc1
    buffer_load_dwordx4 v[144:147], v10, s[56:59], s82 offen offset:2048 sc1
    buffer_load_dwordx4 v[148:151], v10, s[56:59], s82 offen offset:3072 sc1
    s_add_u32 s82, s94, 57344
    buffer_load_dwordx4 v[152:155], v10, s[56:59], s82 offen offset:0 sc1
    buffer_load_dwordx4 v[156:159], v10, s[56:59], s82 offen offset:1024 sc1
    buffer_load_dwordx4 v[160:163], v10, s[56:59], s82 offen offset:2048 sc1
    buffer_load_dwordx4 v[164:167], v10, s[56:59], s82 offen offset:3072 sc1
    s_waitcnt lgkmcnt(8)
    v_mfma_f32_32x32x16_bf16 v[40:55], v[32:35], v[176:179], v[40:55]
    v_mfma_f32_32x32x16_bf16 v[56:71], v[36:39], v[176:179], v[56:71]
    ds_read_b64_tr_b16 v[24:25], v4 offset:34816
    ds_read_b64_tr_b16 v[26:27], v4 offset:35840
    ds_read_b64_tr_b16 v[28:29], v5 offset:34816
    ds_read_b64_tr_b16 v[30:31], v5 offset:35840
    s_waitcnt lgkmcnt(8)
    v_mfma_f32_32x32x16_bf16 v[40:55], v[236:239], v[180:183], v[40:55]
    v_mfma_f32_32x32x16_bf16 v[56:71], v[240:243], v[180:183], v[56:71]
    ds_read_b64_tr_b16 v[32:33], v4 offset:49152
    ds_read_b64_tr_b16 v[34:35], v4 offset:50176
    ds_read_b64_tr_b16 v[36:37], v5 offset:49152
    ds_read_b64_tr_b16 v[38:39], v5 offset:50176
    s_waitcnt lgkmcnt(8)
    v_mfma_f32_32x32x16_bf16 v[40:55], v[16:19], v[184:187], v[40:55]
    v_mfma_f32_32x32x16_bf16 v[56:71], v[20:23], v[184:187], v[56:71]
    ds_read_b64_tr_b16 v[236:237], v4 offset:51200
    ds_read_b64_tr_b16 v[238:239], v4 offset:52224
    ds_read_b64_tr_b16 v[240:241], v5 offset:51200
    ds_read_b64_tr_b16 v[242:243], v5 offset:52224
    s_waitcnt lgkmcnt(8)
    v_mfma_f32_32x32x16_bf16 v[40:55], v[24:27], v[188:191], v[40:55]
    v_mfma_f32_32x32x16_bf16 v[56:71], v[28:31], v[188:191], v[56:71]
    s_waitcnt lgkmcnt(4)
    v_mfma_f32_32x32x16_bf16 v[40:55], v[32:35], v[192:195], v[40:55]
    v_mfma_f32_32x32x16_bf16 v[56:71], v[36:39], v[192:195], v[56:71]
    s_waitcnt lgkmcnt(0)
    v_mfma_f32_32x32x16_bf16 v[40:55], v[236:239], v[196:199], v[40:55]
    v_mfma_f32_32x32x16_bf16 v[56:71], v[240:243], v[196:199], v[56:71]
    s_setprio 2
    s_branch Ltkw_120
Ltk_118:
    s_add_u32 s82, s94, 32768
Lpb_121:
    buffer_load_dword v249, v248, s[56:59], s82 offen offset:1008 sc1
    s_waitcnt vmcnt(0)
    v_cmp_eq_u32 vcc, -1, v249
    s_cbranch_vccz Lpbd_122
    s_cmp_eq_u32 s77, 0
    s_cbranch_scc1 Lpbd_122
    s_sub_u32 s77, s77, 1
    s_sleep 8
    s_branch Lpb_121
Lpbd_122:
    s_add_u32 s82, s94, 32768
    buffer_load_dwordx4 v[104:107], v10, s[56:59], s82 offen offset:0 sc1
    buffer_load_dwordx4 v[108:111], v10, s[56:59], s82 offen offset:1024 sc1
    buffer_load_dwordx4 v[112:115], v10, s[56:59], s82 offen offset:2048 sc1
    buffer_load_dwordx4 v[116:119], v10, s[56:59], s82 offen offset:3072 sc1
    s_add_u32 s82, s94, 40960
    buffer_load_dwordx4 v[120:123], v10, s[56:59], s82 offen offset:0 sc1
    buffer_load_dwordx4 v[124:127], v10, s[56:59], s82 offen offset:1024 sc1
    buffer_load_dwordx4 v[128:131], v10, s[56:59], s82 offen offset:2048 sc1
    buffer_load_dwordx4 v[132:135], v10, s[56:59], s82 offen offset:3072 sc1
    s_add_u32 s82, s94, 49152
    buffer_load_dwordx4 v[136:139], v10, s[56:59], s82 offen offset:0 sc1
    buffer_load_dwordx4 v[140:143], v10, s[56:59], s82 offen offset:1024 sc1
    buffer_load_dwordx4 v[144:147], v10, s[56:59], s82 offen offset:2048 sc1
    buffer_load_dwordx4 v[148:151], v10, s[56:59], s82 offen offset:3072 sc1
    s_add_u32 s82, s94, 57344
    buffer_load_dwordx4 v[152:155], v10, s[56:59], s82 offen offset:0 sc1
    buffer_load_dwordx4 v[156:159], v10, s[56:59], s82 offen offset:1024 sc1
    buffer_load_dwordx4 v[160:163], v10, s[56:59], s82 offen offset:2048 sc1
    buffer_load_dwordx4 v[164:167], v10, s[56:59], s82 offen offset:3072 sc1
Ltkw_120:
    s_waitcnt vmcnt(0)
    v_max_u32 v3, v104, v108
    v_max3_u32 v3, v3, v112, v116
    v_max3_u32 v3, v3, v120, v124
    v_max3_u32 v3, v3, v128, v132
    v_max3_u32 v3, v3, v136, v140
    v_max3_u32 v3, v3, v144, v148
    v_max3_u32 v3, v3, v152, v156
    v_max3_u32 v3, v3, v160, v164
    v_cmp_eq_u32 vcc, -1, v3
    s_cbranch_vccz Ltkd_119
    s_cmp_eq_u32 s77, 0
    s_cbranch_scc1 Ltkd_119
    s_sub_u32 s77, s77, 1
    s_branch Ltk_118
Ltkd_119:
    ds_read_b64_tr_b16 v[16:17], v6 offset:16384
    ds_read_b64_tr_b16 v[18:19], v6 offset:17408
    ds_read_b64_tr_b16 v[20:21], v252 offset:16384
    ds_read_b64_tr_b16 v[22:23], v252 offset:17408
    ds_read_b64_tr_b16 v[24:25], v6 offset:18432
    ds_read_b64_tr_b16 v[26:27], v6 offset:19456
    ds_read_b64_tr_b16 v[28:29], v252 offset:18432
    ds_read_b64_tr_b16 v[30:31], v252 offset:19456
    ds_read_b64_tr_b16 v[32:33], v6 offset:20480
    ds_read_b64_tr_b16 v[34:35], v6 offset:21504
    ds_read_b64_tr_b16 v[36:37], v252 offset:20480
    ds_read_b64_tr_b16 v[38:39], v252 offset:21504
    s_setprio 0
    v_mfma_f32_32x32x16_bf16 v[40:55], v[72:75], v[104:107], v[40:55]
    v_mfma_f32_32x32x16_bf16 v[56:71], v[76:79], v[104:107], v[56:71]
    v_mfma_f32_32x32x16_bf16 v[40:55], v[80:83], v[108:111], v[40:55]
    v_mfma_f32_32x32x16_bf16 v[56:71], v[84:87], v[108:111], v[56:71]
    v_mfma_f32_32x32x16_bf16 v[40:55], v[88:91], v[112:115], v[40:55]
    v_mfma_f32_32x32x16_bf16 v[56:71], v[92:95], v[112:115], v[56:71]
    v_mfma_f32_32x32x16_bf16 v[40:55], v[96:99], v[116:119], v[40:55]
    v_mfma_f32_32x32x16_bf16 v[56:71], v[100:103], v[116:119], v[56:71]
    s_waitcnt lgkmcnt(8)
    v_mfma_f32_32x32x16_bf16 v[40:55], v[16:19], v[120:123], v[40:55]
    v_mfma_f32_32x32x16_bf16 v[56:71], v[20:23], v[120:123], v[56:71]
    ds_read_b64_tr_b16 v[236:237], v6 offset:22528
    ds_read_b64_tr_b16 v[238:239], v6 offset:23552
    ds_read_b64_tr_b16 v[240:241], v252 offset:22528
    ds_read_b64_tr_b16 v[242:243], v252 offset:23552
    s_add_u32 s82, s94, 0
    buffer_load_dwordx4 v[200:203], v10, s[56:59], s82 offen offset:2048 sc1
    s_add_u32 s82, s94, 8192
    buffer_load_dwordx4 v[204:207], v10, s[56:59], s82 offen offset:2048 sc1
    s_add_u32 s82, s94, 16384
    buffer_load_dwordx4 v[208:211], v10, s[56:59], s82 offen offset:2048 sc1
    s_add_u32 s82, s94, 24576
    buffer_load_dwordx4 v[212:215], v10, s[56:59], s82 offen offset:2048 sc1
    s_waitcnt lgkmcnt(8)
    v_mfma_f32_32x32x16_bf16 v[40:55], v[24:27], v[124:127], v[40:55]
    v_mfma_f32_32x32x16_bf16 v[56:71], v[28:31], v[124:127], v[56:71]
    s_waitcnt lgkmcnt(4)
    v_mfma_f32_32x32x16_bf16 v[40:55], v[32:35], v[128:131], v[40:55]
    v_mfma_f32_32x32x16_bf16 v[56:71], v[36:39], v[128:131], v[56:71]
    s_waitcnt lgkmcnt(0)
    v_mfma_f32_32x32x16_bf16 v[40:55], v[236:239], v[132:135], v[40:55]
    v_mfma_f32_32x32x16_bf16 v[56:71], v[240:243], v[132:135], v[56:71]
    s_setprio 2
    s_branch Ltkw_125
Ltk_123:
    v_mov_b32 v13, 160824
Lcf_126:
    ds_read_b32 v3, v13
    s_waitcnt lgkmcnt(0)
    v_cmp_eq_u32 vcc, 0, v3
    s_cbranch_vccz Lcfd_127
    s_cmp_eq_u32 s77, 0
    s_cbranch_scc1 Lcfd_127
    s_sub_u32 s77, s77, 1
    s_sleep 2
    s_branch Lcf_126
Lcfd_127:
    s_add_u32 s82, s94, 0
    buffer_load_dwordx4 v[200:203], v10, s[56:59], s82 offen offset:2048 sc1
    s_add_u32 s82, s94, 8192
    buffer_load_dwordx4 v[204:207], v10, s[56:59], s82 offen offset:2048 sc1
    s_add_u32 s82, s94, 16384
    buffer_load_dwordx4 v[208:211], v10, s[56:59], s82 offen offset:2048 sc1
    s_add_u32 s82, s94, 24576
    buffer_load_dwordx4 v[212:215], v10, s[56:59], s82 offen offset:2048 sc1
Ltkw_125:
    s_waitcnt vmcnt(0)
    v_max_u32 v3, v200, v204
    v_max3_u32 v3, v3, v208, v212
    v_cmp_eq_u32 vcc, -1, v3
    s_cbranch_vccz Ltkd_124
    s_cmp_eq_u32 s77, 0
    s_cbranch_scc1 Ltkd_124
    s_sub_u32 s77, s77, 1
    s_sleep 3
    s_branch Ltk_123
Ltkd_124:
    ds_read_b64_tr_b16 v[16:17], v252 offset:32768
    ds_read_b64_tr_b16 v[18:19], v252 offset:33792
    ds_read_b64_tr_b16 v[20:21], v252 offset:34816
    ds_read_b64_tr_b16 v[22:23], v252 offset:35840
    ds_read_b64_tr_b16 v[24:25], v252 offset:36864
    ds_read_b64_tr_b16 v[26:27], v252 offset:37888
    ds_read_b64_tr_b16 v[28:29], v252 offset:38912
    ds_read_b64_tr_b16 v[30:31], v252 offset:39936
    ds_read_b64_tr_b16 v[32:33], v252 offset:0
    ds_read_b64_tr_b16 v[34:35], v252 offset:1024
    ds_read_b64_tr_b16 v[36:37], v252 offset:2048
    ds_read_b64_tr_b16 v[38:39], v252 offset:3072
    v_and_b32 v14, 31, v0
    v_lshlrev_b32 v14, 10, v14
    v_lshrrev_b32 v15, 5, v0
    v_lshl_add_u32 v14, v15, 4, v14
    s_lshl_b32 s85, s73, 16
    s_lshl_b32 s82, s79, 15
    s_add_u32 s85, s85, s82
    s_lshl_b32 s82, s74, 7
    s_add_u32 s85, s85, s82
    s_lshl_b32 s82, s80, 6
    s_add_u32 s85, s85, s82
    s_add_u32 s84, s85, 16384
    s_lshl_b32 s83, s78, 12
    s_add_u32 s81, s83, 74752
    v_add_u32 v254, s81, v10
    s_xor_b32 s83, s83, 4096
    s_add_u32 s81, s83, 74752
    v_add_u32 v253, s81, v10
    s_lshl_b32 s81, s78, 8
    s_add_u32 s81, s81, 159952
    v_mov_b32 v13, s81
    ds_read_b64_tr_b16 v[168:169], v7 offset:6144
    ds_read_b64_tr_b16 v[170:171], v7 offset:7168
    ds_read_b64_tr_b16 v[172:173], v7 offset:14336
    ds_read_b64_tr_b16 v[174:175], v7 offset:15360
    ds_read_b64_tr_b16 v[176:177], v7 offset:22528
    ds_read_b64_tr_b16 v[178:179], v7 offset:23552
    ds_read_b64_tr_b16 v[180:181], v7 offset:30720
    ds_read_b64_tr_b16 v[182:183], v7 offset:31744
    ds_read_b64_tr_b16 v[184:185], v7 offset:38912
    ds_read_b64_tr_b16 v[186:187], v7 offset:39936
    ds_read_b64_tr_b16 v[188:189], v7 offset:47104
    ds_read_b64_tr_b16 v[190:191], v7 offset:48128
    ds_read_b64_tr_b16 v[192:193], v7 offset:55296
    ds_read_b64_tr_b16 v[194:195], v7 offset:56320
    ds_read_b64_tr_b16 v[196:197], v7 offset:63488
    ds_read_b64_tr_b16 v[198:199], v7 offset:64512
    s_branch Ltw_128
.p2align 12, , 2200
Ltw_128:
    ds_read_b32 v3, v13
    s_waitcnt lgkmcnt(0)
    v_cmp_eq_u32 vcc, 0, v3
    s_cbranch_vccz Ltwd_129
    s_cmp_eq_u32 s77, 0
    s_cbranch_scc1 Ltwd_129
    s_sub_u32 s77, s77, 1
    s_sleep 1
    s_branch Ltw_128
Ltwd_129:
    v_mfma_f32_32x32x16_bf16 v[56:71], v[16:19], v[136:139], v[56:71]
    ds_read_b64_tr_b16 v[236:237], v252 offset:4096
    ds_read_b64_tr_b16 v[238:239], v252 offset:5120
    v_mfma_f32_32x32x16_bf16 v[56:71], v[20:23], v[140:143], v[56:71]
    ds_read_b64_tr_b16 v[240:241], v252 offset:6144
    ds_read_b64_tr_b16 v[242:243], v252 offset:7168
    v_mfma_f32_32x32x16_bf16 v[56:71], v[24:27], v[144:147], v[56:71]
    ds_read_b64_tr_b16 v[16:17], v5 offset:4096
    ds_read_b64_tr_b16 v[18:19], v5 offset:5120
    v_mfma_f32_32x32x16_bf16 v[56:71], v[28:31], v[148:151], v[56:71]
    ds_read_b64_tr_b16 v[20:21], v5 offset:20480
    ds_read_b64_tr_b16 v[22:23], v5 offset:21504
    v_mfma_f32_32x32x16_bf16 v[56:71], v[32:35], v[152:155], v[56:71]
    ds_read_b64_tr_b16 v[24:25], v5 offset:36864
    ds_read_b64_tr_b16 v[26:27], v5 offset:37888
    v_mfma_f32_32x32x16_bf16 v[56:71], v[36:39], v[156:159], v[56:71]
    ds_read_b64_tr_b16 v[28:29], v5 offset:53248
    ds_read_b64_tr_b16 v[30:31], v5 offset:54272
    s_waitcnt lgkmcnt(10)
    v_mfma_f32_32x32x16_bf16 v[56:71], v[236:239], v[160:163], v[56:71]
    ds_read_b64_tr_b16 v[32:33], v6 offset:32768
    ds_read_b64_tr_b16 v[34:35], v6 offset:33792
    s_waitcnt lgkmcnt(10)
    v_mfma_f32_32x32x16_bf16 v[56:71], v[240:243], v[164:167], v[56:71]
    ds_read_b64_tr_b16 v[36:37], v6 offset:34816
    ds_read_b64_tr_b16 v[38:39], v6 offset:35840
    s_waitcnt lgkmcnt(10)
    v_mfma_f32_32x32x16_bf16 v[56:71], v[16:19], v[200:203], v[56:71]
    ds_read_b64_tr_b16 v[236:237], v6 offset:36864
    ds_read_b64_tr_b16 v[238:239], v6 offset:37888
    s_waitcnt lgkmcnt(10)
    v_mfma_f32_32x32x16_bf16 v[56:71], v[20:23], v[204:207], v[56:71]
    ds_read_b64_tr_b16 v[240:241], v6 offset:38912
    ds_read_b64_tr_b16 v[242:243], v6 offset:39936
    s_waitcnt lgkmcnt(10)
    v_mfma_f32_32x32x16_bf16 v[56:71], v[24:27], v[208:211], v[56:71]
    ds_read_b64_tr_b16 v[16:17], v6 offset:0
    ds_read_b64_tr_b16 v[18:19], v6 offset:1024
    s_waitcnt lgkmcnt(10)
    v_mfma_f32_32x32x16_bf16 v[56:71], v[28:31], v[212:215], v[56:71]
    ds_read_b64_tr_b16 v[20:21], v6 offset:2048
    ds_read_b64_tr_b16 v[22:23], v6 offset:3072
    s_waitcnt lgkmcnt(10)
    v_mfma_f32_32x32x16_bf16 v[40:55], v[32:35], v[136:139], v[40:55]
    ds_read_b64_tr_b16 v[24:25], v6 offset:4096
    ds_read_b64_tr_b16 v[26:27], v6 offset:5120
    s_waitcnt lgkmcnt(10)
    v_mfma_f32_32x32x16_bf16 v[40:55], v[36:39], v[140:143], v[40:55]
    ds_read_b64_tr_b16 v[28:29], v6 offset:6144
    ds_read_b64_tr_b16 v[30:31], v6 offset:7168
    s_nop 1
    ds_write_b128 v254, v[56:59] offset:0
    ds_write_b128 v254, v[60:63] offset:1024
    ds_write_b128 v254, v[64:67] offset:2048
    ds_write_b128 v254, v[68:71] offset:3072
    s_mov_b64 exec, 1
    ds_add_u32 v2, v1 offset:84
    s_mov_b64 exec, -1
    s_waitcnt lgkmcnt(15)
    v_mfma_f32_32x32x16_bf16 v[40:55], v[236:239], v[144:147], v[40:55]
    ds_read_b64_tr_b16 v[32:33], v4 offset:4096
    ds_read_b64_tr_b16 v[34:35], v4 offset:5120
    s_waitcnt lgkmcnt(15)
    v_mfma_f32_32x32x16_bf16 v[40:55], v[240:243], v[148:151], v[40:55]
    ds_read_b64_tr_b16 v[36:37], v4 offset:20480
    ds_read_b64_tr_b16 v[38:39], v4 offset:21504
    s_waitcnt lgkmcnt(15)
    v_mfma_f32_32x32x16_bf16 v[40:55], v[16:19], v[152:155], v[40:55]
    ds_read_b64_tr_b16 v[236:237], v4 offset:36864
    ds_read_b64_tr_b16 v[238:239], v4 offset:37888
    s_waitcnt lgkmcnt(15)
    v_mfma_f32_32x32x16_bf16 v[40:55], v[20:23], v[156:159], v[40:55]
    ds_read_b64_tr_b16 v[240:241], v4 offset:53248
    ds_read_b64_tr_b16 v[242:243], v4 offset:54272
    s_waitcnt lgkmcnt(15)
    v_mfma_f32_32x32x16_bf16 v[40:55], v[24:27], v[160:163], v[40:55]
    ds_read_b32 v3, v2 offset:84
    s_waitcnt lgkmcnt(14)
    v_mfma_f32_32x32x16_bf16 v[40:55], v[28:31], v[164:167], v[40:55]
    s_add_u32 s82, s93, 0
    buffer_load_dwordx4 v[72:75], v10, s[56:59], s82 offen offset:3072 sc1
    s_add_u32 s82, s93, 4096
    buffer_load_dwordx4 v[76:79], v10, s[56:59], s82 offen offset:3072 sc1
    s_waitcnt lgkmcnt(7)
    v_mfma_f32_32x32x16_bf16 v[40:55], v[32:35], v[200:203], v[40:55]
    s_add_u32 s82, s93, 8192
    buffer_load_dwordx4 v[80:83], v10, s[56:59], s82 offen offset:3072 sc1
    s_add_u32 s82, s93, 12288
    buffer_load_dwordx4 v[84:87], v10, s[56:59], s82 offen offset:3072 sc1
    s_waitcnt lgkmcnt(0)
Lsbr_131:
    v_readfirstlane_b32 s81, v3
    s_cmp_ge_u32 s81, 2
    s_cbranch_scc1 Lsbd_130
    s_cmp_eq_u32 s77, 0
    s_cbranch_scc1 Lsbd_130
    s_sub_u32 s77, s77, 1
    ds_read_b32 v3, v2 offset:84
    s_waitcnt lgkmcnt(0)
    s_branch Lsbr_131
Lsbd_130:
    ds_read_b128 v[56:59], v253 offset:0
    ds_read_b128 v[60:63], v253 offset:1024
    ds_read_b128 v[64:67], v253 offset:2048
    ds_read_b128 v[68:71], v253 offset:3072
    v_mfma_f32_32x32x16_bf16 v[40:55], v[36:39], v[204:207], v[40:55]
    s_add_u32 s82, s93, 16384
    buffer_load_dwordx4 v[88:91], v10, s[56:59], s82 offen offset:3072 sc1
    s_add_u32 s82, s93, 20480
    buffer_load_dwordx4 v[92:95], v10, s[56:59], s82 offen offset:3072 sc1
    v_mfma_f32_32x32x16_bf16 v[40:55], v[236:239], v[208:211], v[40:55]
    s_add_u32 s82, s93, 24576
    buffer_load_dwordx4 v[96:99], v10, s[56:59], s82 offen offset:3072 sc1
    s_add_u32 s82, s93, 28672
    buffer_load_dwordx4 v[100:103], v10, s[56:59], s82 offen offset:3072 sc1
    v_mfma_f32_32x32x16_bf16 v[40:55], v[240:243], v[212:215], v[40:55]
    s_waitcnt lgkmcnt(0)
Lr7_132:
    s_waitcnt vmcnt(7)
    v_mfma_f32_32x32x16_bf16 v[136:151], v[168:171], v[72:75], v[56:71]
    v_max_u32 v3, v72, v73
    v_max3_u32 v3, v3, v74, v75
    s_waitcnt vmcnt(6)
    v_mfma_f32_32x32x16_bf16 v[136:151], v[172:175], v[76:79], v[136:151]
    v_max3_u32 v3, v3, v76, v77
    v_max3_u32 v3, v3, v78, v79
    s_waitcnt vmcnt(5)
    v_mfma_f32_32x32x16_bf16 v[136:151], v[176:179], v[80:83], v[136:151]
    v_max3_u32 v3, v3, v80, v81
    v_max3_u32 v3, v3, v82, v83
    s_waitcnt vmcnt(4)
    v_mfma_f32_32x32x16_bf16 v[136:151], v[180:183], v[84:87], v[136:151]
    v_max3_u32 v3, v3, v84, v85
    v_max3_u32 v3, v3, v86, v87
    v_cmp_eq_u32 vcc, -1, v3
    s_cbranch_vccnz Lr7r_133
    s_waitcnt vmcnt(3)
    v_mfma_f32_32x32x16_bf16 v[136:151], v[184:187], v[88:91], v[136:151]
    v_max3_u32 v3, v3, v88, v89
    v_max3_u32 v3, v3, v90, v91
    s_waitcnt vmcnt(2)
    v_mfma_f32_32x32x16_bf16 v[136:151], v[188:191], v[92:95], v[136:151]
    v_max3_u32 v3, v3, v92, v93
    v_max3_u32 v3, v3, v94, v95
    s_waitcnt vmcnt(1)
    v_mfma_f32_32x32x16_bf16 v[136:151], v[192:195], v[96:99], v[136:151]
    v_max3_u32 v3, v3, v96, v97
    v_max3_u32 v3, v3, v98, v99
    s_waitcnt vmcnt(0)
    v_mfma_f32_32x32x16_bf16 v[136:151], v[196:199], v[100:103], v[136:151]
    v_max3_u32 v3, v3, v100, v101
    v_max3_u32 v3, v3, v102, v103
    v_cmp_eq_u32 vcc, -1, v3
    s_cbranch_vccnz Lr7r_133
Lr7d_134:
    s_nop 7
    v_pk_add_f32 v[40:41], v[40:41], v[136:137]
    v_pk_add_f32 v[42:43], v[42:43], v[138:139]
    v_pk_add_f32 v[44:45], v[44:45], v[140:141]
    v_pk_add_f32 v[46:47], v[46:47], v[142:143]
    v_pk_add_f32 v[48:49], v[48:49], v[144:145]
    v_pk_add_f32 v[50:51], v[50:51], v[146:147]
    v_pk_add_f32 v[52:53], v[52:53], v[148:149]
    v_pk_add_f32 v[54:55], v[54:55], v[150:151]
    v_cvt_pk_bf16_f32 v24, v40, v41
    v_cvt_pk_bf16_f32 v25, v42, v43
    v_cvt_pk_bf16_f32 v26, v44, v45
    v_cvt_pk_bf16_f32 v27, v46, v47
    v_cvt_pk_bf16_f32 v28, v48, v49
    v_cvt_pk_bf16_f32 v29, v50, v51
    v_cvt_pk_bf16_f32 v30, v52, v53
    v_cvt_pk_bf16_f32 v31, v54, v55
    v_permlane32_swap_b32 v24, v26
    v_permlane32_swap_b32 v25, v27
    buffer_store_dwordx4 v[24:27], v14, s[60:63], s85 offen offset:0
    v_permlane32_swap_b32 v28, v30
    v_permlane32_swap_b32 v29, v31
    buffer_store_dwordx4 v[28:31], v14, s[60:63], s85 offen offset:32
L_exit:
    s_endpgm
Lr7r_133:
    s_cmp_eq_u32 s77, 0
    s_cbranch_scc1 Lr7d_134
    s_sub_u32 s77, s77, 1
    s_add_u32 s82, s93, 0
    buffer_load_dwordx4 v[72:75], v10, s[56:59], s82 offen offset:3072 sc1
    s_add_u32 s82, s93, 4096
    buffer_load_dwordx4 v[76:79], v10, s[56:59], s82 offen offset:3072 sc1
    s_add_u32 s82, s93, 8192
    buffer_load_dwordx4 v[80:83], v10, s[56:59], s82 offen offset:3072 sc1
    s_add_u32 s82, s93, 12288
    buffer_load_dwordx4 v[84:87], v10, s[56:59], s82 offen offset:3072 sc1
    s_add_u32 s82, s93, 16384
    buffer_load_dwordx4 v[88:91], v10, s[56:59], s82 offen offset:3072 sc1
    s_add_u32 s82, s93, 20480
    buffer_load_dwordx4 v[92:95], v10, s[56:59], s82 offen offset:3072 sc1
    s_add_u32 s82, s93, 24576
    buffer_load_dwordx4 v[96:99], v10, s[56:59], s82 offen offset:3072 sc1
    s_add_u32 s82, s93, 28672
    buffer_load_dwordx4 v[100:103], v10, s[56:59], s82 offen offset:3072 sc1
    s_branch Lr7_132
L_fin:
    s_nop 1
    s_and_b32 s83, s87, 3
    s_lshl_b32 s81, s83, 10
    s_add_u32 s81, s81, 156672
    v_and_b32 v14, 3, v0
    v_lshl_add_u32 v14, v14, 8, s81
    v_and_b32 v15, 124, v251
    v_add_u32 v15, s81, v15
    s_lshl_b32 s82, s87, 10
    s_add_u32 s82, s82, 67584
    s_lshl_b32 s83, s83, 13
    s_add_u32 s83, s83, 74752
    v_add_u32 v140, s83, v10
    s_lshl_b32 s81, s87, 2
    s_add_u32 s81, s81, 160800
    v_mov_b32 v13, s81
    s_lshr_b32 s81, s87, 2
    s_lshl_b32 s83, s73, 1
    s_add_u32 s81, s81, s83
    s_lshl_b32 s81, s81, 6
    s_lshl_b32 s83, s74, 2
    s_add_u32 s81, s81, s83
    s_and_b32 s83, s87, 3
    s_add_u32 s81, s81, s83
    s_lshl_b32 s85, s81, 10
    s_add_u32 s85, s85, 4194304
Lfw_135:
    ds_read_b32 v3, v14 offset:208
    s_waitcnt lgkmcnt(0)
    v_cmp_eq_u32 vcc, 0, v3
    s_cbranch_vccz Lfwd_136
    s_cmp_eq_u32 s77, 0
    s_cbranch_scc1 Lfwd_136
    s_sub_u32 s77, s77, 1
    s_sleep 2
    s_branch Lfw_135
Lfwd_136:
    ds_read_b128 v[104:107], v140 offset:0
    ds_read_b128 v[108:111], v140 offset:1024
    ds_read_b32 v136, v15 offset:0
    ds_read_b128 v[112:115], v140 offset:2048
    ds_read_b128 v[116:119], v140 offset:3072
    ds_read_b32 v137, v15 offset:256
    ds_read_b128 v[120:123], v140 offset:4096
    ds_read_b128 v[124:127], v140 offset:5120
    ds_read_b32 v138, v15 offset:512
    ds_read_b128 v[128:131], v140 offset:6144
    ds_read_b128 v[132:135], v140 offset:7168
    ds_read_b32 v139, v15 offset:768
    ds_write_b32 v14, v250 offset:208
    ds_write_b32 v13, v1
    s_waitcnt lgkmcnt(2)
    v_pk_add_f32 v[104:105], v[104:105], v[112:113]
    v_pk_add_f32 v[120:121], v[120:121], v[128:129]
    v_pk_add_f32 v[106:107], v[106:107], v[114:115]
    v_pk_add_f32 v[122:123], v[122:123], v[130:131]
    v_pk_add_f32 v[108:109], v[108:109], v[116:117]
    v_pk_add_f32 v[124:125], v[124:125], v[132:133]
    v_pk_add_f32 v[110:111], v[110:111], v[118:119]
    v_pk_add_f32 v[126:127], v[126:127], v[134:135]
    v_pk_add_f32 v[136:137], v[136:137], v[138:139]
    v_pk_add_f32 v[104:105], v[104:105], v[120:121]
    v_pk_add_f32 v[106:107], v[106:107], v[122:123]
    v_pk_add_f32 v[108:109], v[108:109], v[124:125]
    v_pk_add_f32 v[110:111], v[110:111], v[126:127]
    v_add_f32 v112, v136, v137
    v_pk_mul_f32 v[114:115], v[104:105], 0 op_sel_hi:[1,0]
    v_pk_fma_f32 v[114:115], v[106:107], 0, v[114:115] op_sel_hi:[1,0,1]
    v_pk_fma_f32 v[114:115], v[108:109], 0, v[114:115] op_sel_hi:[1,0,1]
    v_pk_fma_f32 v[114:115], v[110:111], 0, v[114:115] op_sel_hi:[1,0,1]
    v_add_f32 v114, v114, v115
    v_add_f32 v114, v114, v112
    v_cmp_nle_f32 vcc, 0x2b800000, v114
    s_cbranch_vccnz L_fb
    v_cmp_nge_f32 vcc, 0x67800000, v114
    s_cbranch_vccnz L_fb
L_fin_norm:
    v_rcp_f32 v112, v112
    s_nop 0
    v_mul_f32 v112, v112, v233
    v_pk_mul_f32 v[104:105], v[104:105], v[112:113] op_sel_hi:[1,0]
    v_pk_mul_f32 v[106:107], v[106:107], v[112:113] op_sel_hi:[1,0]
    v_pk_mul_f32 v[108:109], v[108:109], v[112:113] op_sel_hi:[1,0]
    v_pk_mul_f32 v[110:111], v[110:111], v[112:113] op_sel_hi:[1,0]
    v_cvt_pk_bf16_f32 v244, v104, v105
    v_cvt_pk_bf16_f32 v245, v106, v107
    v_cvt_pk_bf16_f32 v246, v108, v109
    v_cvt_pk_bf16_f32 v247, v110, v111
    v_min_u32 v244, -2, v244
    s_cmp_lg_u32 s87, 7
    s_cbranch_scc1 Lmn_137
    v_min_u32 v245, -2, v245
    v_min_u32 v246, -2, v246
    v_min_u32 v247, -2, v247
Lmn_137:
    s_cmp_ge_u32 s87, s91
    s_cbranch_scc1 Lst_138
    buffer_store_dwordx4 v[244:247], v10, s[56:59], s85 offen sc1
    s_branch Lst_139
Lst_138:
    buffer_store_dwordx4 v[244:247], v10, s[56:59], s85 offen nt
Lst_139:
    s_setpc_b64 s[88:89]
Lsbr_40:
    s_cmp_eq_u32 s77, 0
    s_cbranch_scc1 Lsbd_39
    s_sub_u32 s77, s77, 1
    s_sleep 2
    ds_read_b32 v3, v2 offset:0
    s_waitcnt lgkmcnt(0)
    v_readfirstlane_b32 s81, v3
    s_cmp_lt_u32 s81, 4
    s_cbranch_scc1 Lsbr_40
    s_branch Lsbd_39
Lgl_41:
    s_cmp_eq_u32 s77, 0
    s_cbranch_scc1 Lgld_42
    s_sub_u32 s77, s77, 1
    v_and_b32 v14, 124, v251
    buffer_load_dword v11, v14, s[56:59], s83 offen sc1
    buffer_load_dword v12, v14, s[56:59], s84 offen sc1
    s_waitcnt vmcnt(0)
    v_max_u32 v3, v11, v12
    v_cmp_eq_u32 vcc, -1, v3
    s_cbranch_vccnz Lgl_41
    s_branch Lgld_42
Lsbr_44:
    s_cmp_eq_u32 s77, 0
    s_cbranch_scc1 Lsbd_43
    s_sub_u32 s77, s77, 1
    ds_read_b32 v3, v2 offset:36
    s_waitcnt lgkmcnt(0)
    v_readfirstlane_b32 s81, v3
    s_cmp_lt_u32 s81, 4
    s_cbranch_scc1 Lsbr_44
    s_branch Lsbd_43
Lsbr_47:
    s_cmp_eq_u32 s77, 0
    s_cbranch_scc1 Lsbd_46
    s_sub_u32 s77, s77, 1
    ds_read_b32 v3, v2 offset:40
    s_waitcnt lgkmcnt(0)
    v_readfirstlane_b32 s81, v3
    s_cmp_lt_u32 s81, 4
    s_cbranch_scc1 Lsbr_47
    s_branch Lsbd_46
Lsbr_49:
    s_cmp_eq_u32 s77, 0
    s_cbranch_scc1 Lsbd_48
    s_sub_u32 s77, s77, 1
    ds_read_b32 v3, v2 offset:44
    s_waitcnt lgkmcnt(0)
    v_readfirstlane_b32 s81, v3
    s_cmp_lt_u32 s81, 4
    s_cbranch_scc1 Lsbr_49
    s_branch Lsbd_48
Lsbr_51:
    s_cmp_eq_u32 s77, 0
    s_cbranch_scc1 Lsbd_50
    s_sub_u32 s77, s77, 1
    ds_read_b32 v3, v2 offset:48
    s_waitcnt lgkmcnt(0)
    v_readfirstlane_b32 s81, v3
    s_cmp_lt_u32 s81, 4
    s_cbranch_scc1 Lsbr_51
    s_branch Lsbd_50
Lsbr_53:
    s_cmp_eq_u32 s77, 0
    s_cbranch_scc1 Lsbd_52
    s_sub_u32 s77, s77, 1
    ds_read_b32 v3, v2 offset:52
    s_waitcnt lgkmcnt(0)
    v_readfirstlane_b32 s81, v3
    s_cmp_lt_u32 s81, 4
    s_cbranch_scc1 Lsbr_53
    s_branch Lsbd_52
Lsbr_55:
    s_cmp_eq_u32 s77, 0
    s_cbranch_scc1 Lsbd_54
    s_sub_u32 s77, s77, 1
    ds_read_b32 v3, v2 offset:56
    s_waitcnt lgkmcnt(0)
    v_readfirstlane_b32 s81, v3
    s_cmp_lt_u32 s81, 4
    s_cbranch_scc1 Lsbr_55
    s_branch Lsbd_54
Lsbr_61:
    s_cmp_eq_u32 s77, 0
    s_cbranch_scc1 Lsbd_60
    s_sub_u32 s77, s77, 1
    ds_read_b32 v3, v2 offset:60
    s_waitcnt lgkmcnt(0)
    v_readfirstlane_b32 s81, v3
    s_cmp_lt_u32 s81, 4
    s_cbranch_scc1 Lsbr_61
    s_branch Lsbd_60
Lsbr_64:
    s_cmp_eq_u32 s77, 0
    s_cbranch_scc1 Lsbd_63
    s_sub_u32 s77, s77, 1
    ds_read_b32 v3, v2 offset:64
    s_waitcnt lgkmcnt(0)
    v_readfirstlane_b32 s81, v3
    s_cmp_lt_u32 s81, 4
    s_cbranch_scc1 Lsbr_64
    s_branch Lsbd_63
Lpf_71:
    s_cmp_eq_u32 s77, 0
    s_cbranch_scc1 Lpfd_72
    s_sub_u32 s77, s77, 1
    s_sleep 4
    s_mov_b64 exec, vcc
    s_mov_b32 s81, 557056
    buffer_load_dword v249, v254, s[56:59], s81 offen sc1
    s_mov_b64 exec, -1
    s_waitcnt vmcnt(0)
    v_cmp_ne_u32 vcc, s76, v249
    s_cbranch_vccnz Lpf_71
    s_branch Lpfd_72
Lpf_77:
    s_cmp_eq_u32 s77, 0
    s_cbranch_scc1 Lpfd_78
    s_sub_u32 s77, s77, 1
    s_sleep 4
    s_mov_b64 exec, vcc
    s_mov_b32 s81, 557056
    buffer_load_dword v249, v235, s[56:59], s81 offen sc1
    s_mov_b64 exec, -1
    s_waitcnt vmcnt(0)
    v_cmp_ne_u32 vcc, s76, v249
    s_cbranch_vccnz Lpf_77
    s_branch Lpfd_78
Lsbr_84:
    s_cmp_eq_u32 s77, 0
    s_cbranch_scc1 Lsbd_83
    s_sub_u32 s77, s77, 1
    s_sleep 1
    ds_read_b32 v3, v2 offset:68
    s_waitcnt lgkmcnt(0)
    v_readfirstlane_b32 s81, v3
    s_cmp_lt_u32 s81, 4
    s_cbranch_scc1 Lsbr_84
    s_branch Lsbd_83
Lsbr_97:
    s_cmp_eq_u32 s77, 0
    s_cbranch_scc1 Lsbd_96
    s_sub_u32 s77, s77, 1
    s_sleep 2
    ds_read_b32 v3, v2 offset:24
    s_waitcnt lgkmcnt(0)
    v_readfirstlane_b32 s81, v3
    s_cmp_lt_u32 s81, 4
    s_cbranch_scc1 Lsbr_97
    s_branch Lsbd_96
Lsbr_112:
    s_cmp_eq_u32 s77, 0
    s_cbranch_scc1 Lsbd_111
    s_sub_u32 s77, s77, 1
    s_sleep 2
    ds_read_b32 v3, v2 offset:72
    s_waitcnt lgkmcnt(0)
    v_readfirstlane_b32 s81, v3
    s_cmp_lt_u32 s81, 4
    s_cbranch_scc1 Lsbr_112
    s_branch Lsbd_111
CODE_END:
Lff_56:
    v_mfma_f32_32x32x16_bf16 v[72:87], v[16:19], v[24:27], 0
    s_nop 11
    v_max_f32 v88, v72, v73
    v_max3_f32 v88, v88, v74, v75
    v_max3_f32 v88, v88, v76, v77
    v_max3_f32 v88, v88, v78, v79
    v_max3_f32 v88, v88, v80, v81
    v_max3_f32 v88, v88, v82, v83
    v_max3_f32 v88, v88, v84, v85
    v_max3_f32 v88, v88, v86, v87
    v_pk_add_f32 v[72:73], v[72:73], v[88:89] op_sel_hi:[1,0] neg_lo:[0,1] neg_hi:[0,1]
    v_pk_add_f32 v[74:75], v[74:75], v[88:89] op_sel_hi:[1,0] neg_lo:[0,1] neg_hi:[0,1]
    v_pk_add_f32 v[76:77], v[76:77], v[88:89] op_sel_hi:[1,0] neg_lo:[0,1] neg_hi:[0,1]
    v_pk_add_f32 v[78:79], v[78:79], v[88:89] op_sel_hi:[1,0] neg_lo:[0,1] neg_hi:[0,1]
    v_pk_add_f32 v[80:81], v[80:81], v[88:89] op_sel_hi:[1,0] neg_lo:[0,1] neg_hi:[0,1]
    v_pk_add_f32 v[82:83], v[82:83], v[88:89] op_sel_hi:[1,0] neg_lo:[0,1] neg_hi:[0,1]
    v_pk_add_f32 v[84:85], v[84:85], v[88:89] op_sel_hi:[1,0] neg_lo:[0,1] neg_hi:[0,1]
    v_pk_add_f32 v[86:87], v[86:87], v[88:89] op_sel_hi:[1,0] neg_lo:[0,1] neg_hi:[0,1]
    v_exp_f32 v72, v72
    v_exp_f32 v73, v73
    v_exp_f32 v74, v74
    v_exp_f32 v75, v75
    v_exp_f32 v76, v76
    v_exp_f32 v77, v77
    v_exp_f32 v78, v78
    v_exp_f32 v79, v79
    v_exp_f32 v80, v80
    v_exp_f32 v81, v81
    v_exp_f32 v82, v82
    v_exp_f32 v83, v83
    v_exp_f32 v84, v84
    v_exp_f32 v85, v85
    v_exp_f32 v86, v86
    v_exp_f32 v87, v87
    v_pk_add_f32 v[88:89], v[72:73], v[74:75]
    v_pk_add_f32 v[90:91], v[76:77], v[78:79]
    v_pk_add_f32 v[88:89], v[88:89], v[80:81]
    v_pk_add_f32 v[90:91], v[90:91], v[82:83]
    v_pk_add_f32 v[88:89], v[88:89], v[84:85]
    v_pk_add_f32 v[90:91], v[90:91], v[86:87]
    v_pk_add_f32 v[88:89], v[88:89], v[90:91]
    v_add_f32 v88, v88, v89
    s_branch Lffb_57
Lff_58:
    v_mfma_f32_32x32x16_bf16 v[40:55], v[20:23], v[28:31], 0
    s_nop 11
    v_max_f32 v88, v40, v41
    v_max3_f32 v88, v88, v42, v43
    v_max3_f32 v88, v88, v44, v45
    v_max3_f32 v88, v88, v46, v47
    v_max3_f32 v88, v88, v48, v49
    v_max3_f32 v88, v88, v50, v51
    v_max3_f32 v88, v88, v52, v53
    v_max3_f32 v88, v88, v54, v55
    v_pk_add_f32 v[40:41], v[40:41], v[88:89] op_sel_hi:[1,0] neg_lo:[0,1] neg_hi:[0,1]
    v_pk_add_f32 v[42:43], v[42:43], v[88:89] op_sel_hi:[1,0] neg_lo:[0,1] neg_hi:[0,1]
    v_pk_add_f32 v[44:45], v[44:45], v[88:89] op_sel_hi:[1,0] neg_lo:[0,1] neg_hi:[0,1]
    v_pk_add_f32 v[46:47], v[46:47], v[88:89] op_sel_hi:[1,0] neg_lo:[0,1] neg_hi:[0,1]
    v_pk_add_f32 v[48:49], v[48:49], v[88:89] op_sel_hi:[1,0] neg_lo:[0,1] neg_hi:[0,1]
    v_pk_add_f32 v[50:51], v[50:51], v[88:89] op_sel_hi:[1,0] neg_lo:[0,1] neg_hi:[0,1]
    v_pk_add_f32 v[52:53], v[52:53], v[88:89] op_sel_hi:[1,0] neg_lo:[0,1] neg_hi:[0,1]
    v_pk_add_f32 v[54:55], v[54:55], v[88:89] op_sel_hi:[1,0] neg_lo:[0,1] neg_hi:[0,1]
    v_exp_f32 v40, v40
    v_exp_f32 v41, v41
    v_exp_f32 v42, v42
    v_exp_f32 v43, v43
    v_exp_f32 v44, v44
    v_exp_f32 v45, v45
    v_exp_f32 v46, v46
    v_exp_f32 v47, v47
    v_exp_f32 v48, v48
    v_exp_f32 v49, v49
    v_exp_f32 v50, v50
    v_exp_f32 v51, v51
    v_exp_f32 v52, v52
    v_exp_f32 v53, v53
    v_exp_f32 v54, v54
    v_exp_f32 v55, v55
    v_pk_add_f32 v[88:89], v[40:41], v[42:43]
    v_pk_add_f32 v[90:91], v[44:45], v[46:47]
    v_pk_add_f32 v[88:89], v[88:89], v[48:49]
    v_pk_add_f32 v[90:91], v[90:91], v[50:51]
    v_pk_add_f32 v[88:89], v[88:89], v[52:53]
    v_pk_add_f32 v[90:91], v[90:91], v[54:55]
    v_pk_add_f32 v[88:89], v[88:89], v[90:91]
    v_add_f32 v88, v88, v89
    s_branch Lffb_59
Lff_73:
    v_mfma_f32_32x32x16_bf16 v[120:135], v[16:19], v[104:107], 0
    s_nop 11
    v_max_f32 v136, v120, v121
    v_max3_f32 v136, v136, v122, v123
    v_max3_f32 v136, v136, v124, v125
    v_max3_f32 v136, v136, v126, v127
    v_max3_f32 v136, v136, v128, v129
    v_max3_f32 v136, v136, v130, v131
    v_max3_f32 v136, v136, v132, v133
    v_max3_f32 v136, v136, v134, v135
    v_pk_add_f32 v[120:121], v[120:121], v[136:137] op_sel_hi:[1,0] neg_lo:[0,1] neg_hi:[0,1]
    v_pk_add_f32 v[122:123], v[122:123], v[136:137] op_sel_hi:[1,0] neg_lo:[0,1] neg_hi:[0,1]
    v_pk_add_f32 v[124:125], v[124:125], v[136:137] op_sel_hi:[1,0] neg_lo:[0,1] neg_hi:[0,1]
    v_pk_add_f32 v[126:127], v[126:127], v[136:137] op_sel_hi:[1,0] neg_lo:[0,1] neg_hi:[0,1]
    v_pk_add_f32 v[128:129], v[128:129], v[136:137] op_sel_hi:[1,0] neg_lo:[0,1] neg_hi:[0,1]
    v_pk_add_f32 v[130:131], v[130:131], v[136:137] op_sel_hi:[1,0] neg_lo:[0,1] neg_hi:[0,1]
    v_pk_add_f32 v[132:133], v[132:133], v[136:137] op_sel_hi:[1,0] neg_lo:[0,1] neg_hi:[0,1]
    v_pk_add_f32 v[134:135], v[134:135], v[136:137] op_sel_hi:[1,0] neg_lo:[0,1] neg_hi:[0,1]
    v_exp_f32 v120, v120
    v_exp_f32 v121, v121
    v_exp_f32 v122, v122
    v_exp_f32 v123, v123
    v_exp_f32 v124, v124
    v_exp_f32 v125, v125
    v_exp_f32 v126, v126
    v_exp_f32 v127, v127
    v_exp_f32 v128, v128
    v_exp_f32 v129, v129
    v_exp_f32 v130, v130
    v_exp_f32 v131, v131
    v_exp_f32 v132, v132
    v_exp_f32 v133, v133
    v_exp_f32 v134, v134
    v_exp_f32 v135, v135
    v_pk_add_f32 v[136:137], v[120:121], v[122:123]
    v_pk_add_f32 v[138:139], v[124:125], v[126:127]
    v_pk_add_f32 v[136:137], v[136:137], v[128:129]
    v_pk_add_f32 v[138:139], v[138:139], v[130:131]
    v_pk_add_f32 v[136:137], v[136:137], v[132:133]
    v_pk_add_f32 v[138:139], v[138:139], v[134:135]
    v_pk_add_f32 v[136:137], v[136:137], v[138:139]
    v_add_f32 v136, v136, v137
    s_branch Lffb_74
Lff_79:
    v_mfma_f32_32x32x16_bf16 v[144:159], v[20:23], v[108:111], 0
    s_nop 11
    v_max_f32 v136, v144, v145
    v_max3_f32 v136, v136, v146, v147
    v_max3_f32 v136, v136, v148, v149
    v_max3_f32 v136, v136, v150, v151
    v_max3_f32 v136, v136, v152, v153
    v_max3_f32 v136, v136, v154, v155
    v_max3_f32 v136, v136, v156, v157
    v_max3_f32 v136, v136, v158, v159
    v_pk_add_f32 v[144:145], v[144:145], v[136:137] op_sel_hi:[1,0] neg_lo:[0,1] neg_hi:[0,1]
    v_pk_add_f32 v[146:147], v[146:147], v[136:137] op_sel_hi:[1,0] neg_lo:[0,1] neg_hi:[0,1]
    v_pk_add_f32 v[148:149], v[148:149], v[136:137] op_sel_hi:[1,0] neg_lo:[0,1] neg_hi:[0,1]
    v_pk_add_f32 v[150:151], v[150:151], v[136:137] op_sel_hi:[1,0] neg_lo:[0,1] neg_hi:[0,1]
    v_pk_add_f32 v[152:153], v[152:153], v[136:137] op_sel_hi:[1,0] neg_lo:[0,1] neg_hi:[0,1]
    v_pk_add_f32 v[154:155], v[154:155], v[136:137] op_sel_hi:[1,0] neg_lo:[0,1] neg_hi:[0,1]
    v_pk_add_f32 v[156:157], v[156:157], v[136:137] op_sel_hi:[1,0] neg_lo:[0,1] neg_hi:[0,1]
    v_pk_add_f32 v[158:159], v[158:159], v[136:137] op_sel_hi:[1,0] neg_lo:[0,1] neg_hi:[0,1]
    v_exp_f32 v144, v144
    v_exp_f32 v145, v145
    v_exp_f32 v146, v146
    v_exp_f32 v147, v147
    v_exp_f32 v148, v148
    v_exp_f32 v149, v149
    v_exp_f32 v150, v150
    v_exp_f32 v151, v151
    v_exp_f32 v152, v152
    v_exp_f32 v153, v153
    v_exp_f32 v154, v154
    v_exp_f32 v155, v155
    v_exp_f32 v156, v156
    v_exp_f32 v157, v157
    v_exp_f32 v158, v158
    v_exp_f32 v159, v159
    v_pk_add_f32 v[136:137], v[144:145], v[146:147]
    v_pk_add_f32 v[138:139], v[148:149], v[150:151]
    v_pk_add_f32 v[136:137], v[136:137], v[152:153]
    v_pk_add_f32 v[138:139], v[138:139], v[154:155]
    v_pk_add_f32 v[136:137], v[136:137], v[156:157]
    v_pk_add_f32 v[138:139], v[138:139], v[158:159]
    v_pk_add_f32 v[136:137], v[136:137], v[138:139]
    v_add_f32 v136, v136, v137
    s_branch Lffb_80
L_fb:
    s_sub_u32 s82, s82, 1024
    v_add_u32 v14, s82, v10
    ds_read_b128 v[164:167], v14
    v_mov_b32 v244, 0xff800000
    s_mov_b32 s81, 0
    s_waitcnt lgkmcnt(0)
L_fb1:
    buffer_load_dwordx4 v[152:155], v10, s[56:59], s81 offen sc1
    s_waitcnt vmcnt(0)
    v_mfma_f32_32x32x16_bf16 v[120:135], v[152:155], v[164:167], 0
    s_nop 11
    v_max3_f32 v244, v244, v120, v121
    v_max3_f32 v244, v244, v122, v123
    v_max3_f32 v244, v244, v124, v125
    v_max3_f32 v244, v244, v126, v127
    v_max3_f32 v244, v244, v128, v129
    v_max3_f32 v244, v244, v130, v131
    v_max3_f32 v244, v244, v132, v133
    v_max3_f32 v244, v244, v134, v135
    s_add_u32 s81, s81, 2048
    s_cmp_lt_u32 s81, 131072
    s_cbranch_scc1 L_fb1
    v_mov_b32 v245, v244
    s_nop 1
    v_permlane32_swap_b32 v244, v245
    v_max_f32 v244, v244, v245
    v_sub_f32 v136, 0, v244
    v_mov_b32 v104, 0
    v_sub_f32 v137, 0, v244
    v_mov_b32 v105, 0
    v_sub_f32 v138, 0, v244
    v_mov_b32 v106, 0
    v_sub_f32 v139, 0, v244
    v_mov_b32 v107, 0
    v_sub_f32 v140, 0, v244
    v_mov_b32 v108, 0
    v_sub_f32 v141, 0, v244
    v_mov_b32 v109, 0
    v_sub_f32 v142, 0, v244
    v_mov_b32 v110, 0
    v_sub_f32 v143, 0, v244
    v_mov_b32 v111, 0
    v_sub_f32 v144, 0, v244
    v_mov_b32 v112, 0
    v_sub_f32 v145, 0, v244
    v_mov_b32 v113, 0
    v_sub_f32 v146, 0, v244
    v_mov_b32 v114, 0
    v_sub_f32 v147, 0, v244
    v_mov_b32 v115, 0
    v_sub_f32 v148, 0, v244
    v_mov_b32 v116, 0
    v_sub_f32 v149, 0, v244
    v_mov_b32 v117, 0
    v_sub_f32 v150, 0, v244
    v_mov_b32 v118, 0
    v_sub_f32 v151, 0, v244
    v_mov_b32 v119, 0
    v_mov_b32 v15, 0xdddd
    s_mov_b32 s81, 0
L_fb2:
    buffer_load_dwordx4 v[152:155], v10, s[56:59], s81 offen sc1
    buffer_load_dwordx4 v[156:159], v10, s[56:59], s81 offen offset:1024 sc1
    v_mov_b32 v160, 0x3f803f80
    v_mov_b32 v161, 0x3f803f80
    v_mov_b32 v162, 0x3f803f80
    v_mov_b32 v163, 0x3f803f80
    s_waitcnt vmcnt(0)
    v_mfma_f32_32x32x16_bf16 v[120:135], v[152:155], v[164:167], v[136:151]
    v_permlane16_swap_b32 v156, v160
    v_permlane16_swap_b32 v157, v161
    v_permlane16_swap_b32 v158, v162
    v_permlane16_swap_b32 v159, v163
    s_nop 7
    v_exp_f32 v120, v120
    v_exp_f32 v121, v121
    v_exp_f32 v122, v122
    v_exp_f32 v123, v123
    v_exp_f32 v124, v124
    v_exp_f32 v125, v125
    v_exp_f32 v126, v126
    v_exp_f32 v127, v127
    v_exp_f32 v128, v128
    v_exp_f32 v129, v129
    v_exp_f32 v130, v130
    v_exp_f32 v131, v131
    v_exp_f32 v132, v132
    v_exp_f32 v133, v133
    v_exp_f32 v134, v134
    v_exp_f32 v135, v135
    v_smfmac_f32_32x32x32_bf16 v[104:119], v[156:159], v[120:127], v15
    s_nop 0
    v_smfmac_f32_32x32x32_bf16 v[104:119], v[160:163], v[128:135], v15
    s_add_u32 s81, s81, 2048
    s_cmp_lt_u32 s81, 131072
    s_cbranch_scc1 L_fb2
    s_nop 9
    s_branch L_fin_norm
.section .rodata,"a"
.p2align 6
.amdhsa_kernel gated_mix__grouped_kv_mqa__linear_kernel_hedgehog__prompt_kernel
  .amdhsa_next_free_vgpr 256
  .amdhsa_next_free_sgpr 102
  .amdhsa_accum_offset 256
  .amdhsa_group_segment_fixed_size 0
  .amdhsa_kernarg_size 104
  .amdhsa_user_sgpr_count 2
  .amdhsa_user_sgpr_kernarg_segment_ptr 1
  .amdhsa_system_sgpr_workgroup_id_x 1
.end_amdhsa_kernel
```
